```python
import torch

def _softmax(x, axis=-1):
    return torch.softmax(x, dim=axis)
def _gelu(x):
    return torch.nn.functional.gelu(x, approximate="tanh")
def _silu(x):
    return torch.nn.functional.silu(x)
def _sigmoid(x):
    return torch.sigmoid(x)
def _layernorm(x, axis=-1, eps=1e-5):
    m = x.mean(dim=axis, keepdim=True)
    v = x.var(dim=axis, keepdim=True, unbiased=False)
    return (x - m) / torch.sqrt(v + eps)
def _scatter_add(tgt, idx, src, axis=0):
    return tgt.clone().index_add_(axis, idx, src)
def _segment_sum(src, seg, n):
    out = torch.zeros((n,) + src.shape[1:], dtype=src.dtype)
    return out.index_add_(0, seg, src)
def _pad(x, pw):
    flat = tuple(v for pair in reversed(pw) for v in pair)
    return torch.nn.functional.pad(x, flat)

kernel_name = 'gather_scatter__edge_featured_mpnn_gatedgcn__graph'

def setup_inputs():

    _w = (lambda a: (lambda t: t.to(torch.bfloat16) if t.is_floating_point() else t)(torch.as_tensor(a)))
    N, deg, D, De = 25000, 32, 64, max(4, 1)
    E = N * deg
    return {
        "x": _w((lambda *s: torch.randn(*s, dtype=torch.bfloat16) * 0.8)(N, D)),
        "e_attr": _w((lambda *s: torch.randn(*s, dtype=torch.bfloat16) * 0.8)(E, De)),
        "src": _w((lambda lo, hi, *s: torch.randint(lo, hi, s))(0, N, E).to(torch.int64)),
        "dst": _w((lambda lo, hi, *s: torch.randint(lo, hi, s))(0, N, E).to(torch.int64)),
        "w_a": _w((lambda *s: torch.randn(*s, dtype=torch.bfloat16) * 0.8)(D, D)),
        "w_b": _w((lambda *s: torch.randn(*s, dtype=torch.bfloat16) * 0.8)(D, D)),
        "w_c": _w((lambda *s: torch.randn(*s, dtype=torch.bfloat16) * 0.8)(De, D)),
        "w_u": _w((lambda *s: torch.randn(*s, dtype=torch.bfloat16) * 0.05)(D, D)),
        "w_v": _w((lambda *s: torch.randn(*s, dtype=torch.bfloat16) * 0.05)(D, D)),
    }

def reference(x, e_attr, src, dst, w_a, w_b, w_c, w_u, w_v):
    N, D = x.shape
    hv = x @ w_v
    g = x[dst] @ w_a + x[src] @ w_b + e_attr @ w_c
    eta = _sigmoid(g)
    denom = _segment_sum(eta, dst, N) + 1e-6
    eta_n = eta / denom[dst]
    agg = _segment_sum(eta_n * hv[src], dst, N)
    z = x @ w_u + agg
    relu_z = torch.where(z > 0, z, 0 * z)
    return x + relu_z
```

```asm
; @launch kernel=part_kernel grid=(255,1,1) block=(800,1,1) lds=40448
; @launch kernel=main_kernel grid=(256,1,1) block=(512,1,1) lds=161024
.amdgcn_target "amdgcn-amd-amdhsa--gfx950"
.text
.globl part_kernel
.p2align 8
.type part_kernel,@function
part_kernel:
  s_cmp_ge_u32 s2, 250
  s_cbranch_scc1 K1_PACK
  s_load_dwordx2 s[8:9], s[0:1], 24
  s_load_dwordx4 s[4:7], s[0:1], 8
  s_load_dwordx2 s[20:21], s[0:1], 88
  v_lshrrev_b32 v33, 6, v0
  v_lshlrev_b32 v1, 4, v0
  v_readfirstlane_b32 s23, v33
  s_getpc_b64 s[26:27]
CPF1L:
  v_lshlrev_b32 v40, 5, v0
  v_min_u32 v40, K2_END-CPF1L, v40
  global_load_dword v55, v40, s[26:27]
  s_mul_i32 s22, s2, 12800
  v_add_u32 v2, s22, v1
  v_lshlrev_b32 v3, 1, v2
  v_mov_b32 v32, 1
  v_mov_b32 v36, 0
  v_mov_b32 v37, 0
  v_mov_b32 v38, 0
  v_mov_b32 v39, 0
  s_cmp_lg_u32 s23, 0
  s_cbranch_scc1 K1_A
  ds_write_b128 v1, v[36:39] offset:38400
K1_A:
  s_waitcnt lgkmcnt(0)
  global_load_dwordx4 v[4:7], v2, s[8:9]
  s_barrier
  s_waitcnt vmcnt(0)
  global_load_dwordx4 v[8:11], v2, s[6:7]
  global_load_dwordx4 v[12:15], v3, s[4:5]
  global_load_dwordx4 v[16:19], v3, s[4:5] offset:16
  v_lshlrev_b32_sdwa v20, 2, v4 dst_sel:DWORD dst_unused:UNUSED_PAD src0_sel:DWORD src1_sel:BYTE_0
  v_lshlrev_b32_sdwa v21, 2, v5 dst_sel:DWORD dst_unused:UNUSED_PAD src0_sel:DWORD src1_sel:BYTE_0
  v_lshlrev_b32_sdwa v22, 2, v6 dst_sel:DWORD dst_unused:UNUSED_PAD src0_sel:DWORD src1_sel:BYTE_0
  v_lshlrev_b32_sdwa v23, 2, v7 dst_sel:DWORD dst_unused:UNUSED_PAD src0_sel:DWORD src1_sel:BYTE_0
  ds_add_rtn_u32 v24, v20, v32 offset:38400
  ds_add_rtn_u32 v25, v21, v32 offset:38400
  ds_add_rtn_u32 v26, v22, v32 offset:38400
  ds_add_rtn_u32 v27, v23, v32 offset:38400
  s_waitcnt lgkmcnt(0)
  s_barrier
  s_cmp_lg_u32 s23, 0
  s_cbranch_scc1 K1_B
  ds_read_b128 v[36:39], v1 offset:38400
  s_waitcnt lgkmcnt(0)
  v_add_u32 v41, v36, v37
  v_add_u32 v42, v41, v38
  v_add_u32 v43, v42, v39
  v_mov_b32 v44, v43
  s_nop 1
  v_add_u32_dpp v44, v44, v44 row_shr:1 row_mask:0xf bank_mask:0xf
  s_nop 1
  v_add_u32_dpp v44, v44, v44 row_shr:2 row_mask:0xf bank_mask:0xf
  s_nop 1
  v_add_u32_dpp v44, v44, v44 row_shr:4 row_mask:0xf bank_mask:0xf
  s_nop 1
  v_add_u32_dpp v44, v44, v44 row_shr:8 row_mask:0xf bank_mask:0xf
  s_nop 1
  v_add_u32_dpp v44, v44, v44 row_bcast:15 row_mask:0xa bank_mask:0xf
  s_nop 1
  v_add_u32_dpp v44, v44, v44 row_bcast:31 row_mask:0xc bank_mask:0xf
  v_sub_u32 v45, v44, v43
  v_add_u32 v47, v45, v36
  v_add_u32 v48, v45, v41
  v_add_u32 v49, v45, v42
  v_mul_u32_u24 v46, 12, v45
  v_mul_u32_u24 v47, 12, v47
  v_mul_u32_u24 v48, 12, v48
  v_mul_u32_u24 v49, 12, v49
  ds_write_b128 v1, v[46:49] offset:39424
  v_lshl_or_b32 v50, v36, 16, v46
  v_lshl_or_b32 v51, v37, 16, v47
  v_lshl_or_b32 v52, v38, 16, v48
  v_lshl_or_b32 v53, v39, 16, v49
  s_lshl_b32 s24, s2, 10
  s_add_u32 s24, s24, 10485760
  v_add_u32 v54, s24, v1
  global_store_dwordx4 v54, v[50:53], s[20:21]
K1_B:
  s_mul_i32 s22, s2, 38400
  v_add_u32 v2, s22, v1
  v_add_u32 v3, 12800, v2
  v_add_u32 v34, 25600, v2
  v_lshrrev_b32 v4, 8, v4
  v_lshrrev_b32 v5, 8, v5
  v_lshrrev_b32 v6, 8, v6
  v_lshrrev_b32 v7, 8, v7
  s_waitcnt lgkmcnt(0)
  s_barrier
  ds_read_b32 v28, v20 offset:39424
  ds_read_b32 v29, v21 offset:39424
  ds_read_b32 v30, v22 offset:39424
  ds_read_b32 v31, v23 offset:39424
  s_waitcnt vmcnt(2)
  v_lshl_or_b32 v8, v4, 18, v8
  v_lshl_or_b32 v9, v5, 18, v9
  v_lshl_or_b32 v10, v6, 18, v10
  v_lshl_or_b32 v11, v7, 18, v11
  s_waitcnt lgkmcnt(3)
  v_mad_u32_u24 v28, v24, 12, v28
  s_waitcnt lgkmcnt(2)
  v_mad_u32_u24 v29, v25, 12, v29
  s_waitcnt lgkmcnt(1)
  v_mad_u32_u24 v30, v26, 12, v30
  s_waitcnt lgkmcnt(0)
  v_mad_u32_u24 v31, v27, 12, v31
  ds_write_b32 v28, v8 offset:8
  ds_write_b32 v29, v9 offset:8
  ds_write_b32 v30, v10 offset:8
  ds_write_b32 v31, v11 offset:8
  s_waitcnt vmcnt(0)
  ds_write2_b32 v28, v12, v13 offset0:0 offset1:1
  ds_write2_b32 v29, v14, v15 offset0:0 offset1:1
  ds_write2_b32 v30, v16, v17 offset0:0 offset1:1
  ds_write2_b32 v31, v18, v19 offset0:0 offset1:1
  s_waitcnt lgkmcnt(0)
  s_barrier
  ds_read_b128 v[8:11], v1
  ds_read_b128 v[12:15], v1 offset:12800
  ds_read_b128 v[16:19], v1 offset:25600
  s_waitcnt lgkmcnt(2)
  global_store_dwordx4 v2, v[8:11], s[20:21]
  s_waitcnt lgkmcnt(1)
  global_store_dwordx4 v3, v[12:15], s[20:21]
  s_waitcnt lgkmcnt(0)
  global_store_dwordx4 v34, v[16:19], s[20:21]
  s_endpgm
K1_PACK:
  s_cmp_ge_u32 s2, 255
  s_cbranch_scc1 K1_END
  s_load_dwordx2 s[10:11], s[0:1], 32
  s_load_dwordx8 s[12:19], s[0:1], 40
  s_load_dwordx2 s[20:21], s[0:1], 88
  v_lshrrev_b32 v33, 6, v0
  s_nop 0
  v_readfirstlane_b32 s23, v33
  s_cmp_ge_u32 s23, 4
  s_cbranch_scc1 K1_END
  s_waitcnt lgkmcnt(0)
  v_and_b32 v2, 31, v0
  v_bfe_u32 v3, v0, 5, 1
  v_and_b32 v34, 63, v0
  s_cmp_eq_u32 s2, 254
  s_cbranch_scc1 K1_PACKC
  s_mov_b32 s24, s12
  s_mov_b32 s25, s13
  s_mov_b32 s26, 0xbfb8aa3b
  s_cmp_eq_u32 s2, 250
  s_cbranch_scc1 K1_P1
  s_mov_b32 s26, 1.0
  s_mov_b32 s24, s18
  s_mov_b32 s25, s19
  s_cmp_eq_u32 s2, 251
  s_cbranch_scc1 K1_P1
  s_mov_b32 s24, s10
  s_mov_b32 s25, s11
  s_cmp_eq_u32 s2, 252
  s_cbranch_scc1 K1_P1
  s_mov_b32 s24, s16
  s_mov_b32 s25, s17
K1_P1:
  v_lshlrev_b32 v4, 12, v3
  v_lshl_add_u32 v4, v2, 2, v4
  s_lshl_b32 s27, s23, 10
  v_add_u32 v4, s27, v4
  global_load_dword v8, v4, s[24:25] offset:0
  global_load_dword v9, v4, s[24:25] offset:128
  global_load_dword v10, v4, s[24:25] offset:256
  global_load_dword v11, v4, s[24:25] offset:384
  global_load_dword v12, v4, s[24:25] offset:512
  global_load_dword v13, v4, s[24:25] offset:640
  global_load_dword v14, v4, s[24:25] offset:768
  global_load_dword v15, v4, s[24:25] offset:896
  s_waitcnt vmcnt(0)
  v_lshlrev_b32 v16, 16, v8
  v_and_b32 v24, 0xffff0000, v8
  v_mul_f32 v16, s26, v16
  v_mul_f32 v24, s26, v24
  v_lshlrev_b32 v17, 16, v9
  v_and_b32 v25, 0xffff0000, v9
  v_mul_f32 v17, s26, v17
  v_mul_f32 v25, s26, v25
  v_lshlrev_b32 v18, 16, v10
  v_and_b32 v26, 0xffff0000, v10
  v_mul_f32 v18, s26, v18
  v_mul_f32 v26, s26, v26
  v_lshlrev_b32 v19, 16, v11
  v_and_b32 v27, 0xffff0000, v11
  v_mul_f32 v19, s26, v19
  v_mul_f32 v27, s26, v27
  v_lshlrev_b32 v20, 16, v12
  v_and_b32 v28, 0xffff0000, v12
  v_mul_f32 v20, s26, v20
  v_mul_f32 v28, s26, v28
  v_lshlrev_b32 v21, 16, v13
  v_and_b32 v29, 0xffff0000, v13
  v_mul_f32 v21, s26, v21
  v_mul_f32 v29, s26, v29
  v_lshlrev_b32 v22, 16, v14
  v_and_b32 v30, 0xffff0000, v14
  v_mul_f32 v22, s26, v22
  v_mul_f32 v30, s26, v30
  v_lshlrev_b32 v23, 16, v15
  v_and_b32 v31, 0xffff0000, v15
  v_mul_f32 v23, s26, v23
  v_mul_f32 v31, s26, v31
  v_cvt_pk_bf16_f32 v36, v16, v17
  v_cvt_pk_bf16_f32 v40, v24, v25
  v_cvt_pk_bf16_f32 v37, v18, v19
  v_cvt_pk_bf16_f32 v41, v26, v27
  v_cvt_pk_bf16_f32 v38, v20, v21
  v_cvt_pk_bf16_f32 v42, v28, v29
  v_cvt_pk_bf16_f32 v39, v22, v23
  v_cvt_pk_bf16_f32 v43, v30, v31
  s_sub_u32 s27, s2, 250
  s_lshl_b32 s27, s27, 2
  s_add_u32 s27, s27, s23
  s_lshl_b32 s27, s27, 11
  s_add_u32 s27, s27, 10747904
  v_lshlrev_b32 v5, 4, v34
  v_add_u32 v5, s27, v5
  global_store_dwordx4 v5, v[36:39], s[20:21]
  global_store_dwordx4 v5, v[40:43], s[20:21] offset:1024
  s_endpgm
K1_PACKC:
  s_cmp_lg_u32 s23, 0
  s_cbranch_scc1 K1_END
  v_lshlrev_b32 v4, 2, v2
  s_mov_b32 s26, 0xbfb8aa3b
  global_load_dword v8, v4, s[14:15] offset:0
  global_load_dword v9, v4, s[14:15] offset:128
  global_load_dword v10, v4, s[14:15] offset:256
  global_load_dword v11, v4, s[14:15] offset:384
  s_waitcnt vmcnt(0)
  v_lshlrev_b32 v16, 16, v8
  v_and_b32 v24, 0xffff0000, v8
  v_mul_f32 v16, s26, v16
  v_mul_f32 v24, s26, v24
  v_lshlrev_b32 v17, 16, v9
  v_and_b32 v25, 0xffff0000, v9
  v_mul_f32 v17, s26, v17
  v_mul_f32 v25, s26, v25
  v_lshlrev_b32 v18, 16, v10
  v_and_b32 v26, 0xffff0000, v10
  v_mul_f32 v18, s26, v18
  v_mul_f32 v26, s26, v26
  v_lshlrev_b32 v19, 16, v11
  v_and_b32 v27, 0xffff0000, v11
  v_mul_f32 v19, s26, v19
  v_mul_f32 v27, s26, v27
  v_cvt_pk_bf16_f32 v36, v16, v17
  v_cvt_pk_bf16_f32 v37, v18, v19
  v_cvt_pk_bf16_f32 v38, v24, v25
  v_cvt_pk_bf16_f32 v39, v26, v27
  v_cmp_eq_u32 vcc, 0, v3
  v_mov_b32 v40, 0x71800000
  v_mov_b32 v41, 0
  v_cndmask_b32 v36, v40, v36, vcc
  v_cndmask_b32 v37, v41, v37, vcc
  v_cndmask_b32 v38, v40, v38, vcc
  v_cndmask_b32 v39, v41, v39, vcc
  v_lshlrev_b32 v5, 4, v34
  v_add_u32 v5, 10780672, v5
  global_store_dwordx4 v5, v[36:39], s[20:21]
K1_END:
  s_endpgm
.globl main_kernel
.p2align 8
.type main_kernel,@function
main_kernel:
  s_cmp_ge_u32 s2, 256
  s_cbranch_scc1 K2_END
  s_load_dwordx8 s[28:35], s[0:1], 64
  s_load_dwordx2 s[4:5], s[0:1], 0
  v_lshrrev_b32 v36, 6, v0
  v_mov_b32 v4, v0
  v_readfirstlane_b32 s68, v36
  v_and_b32 v5, 63, v0
  s_getpc_b64 s[98:99]
CPF2L:
  v_lshlrev_b32 v39, 5, v0
  v_min_u32 v39, K2_END-CPF2L, v39
  global_load_dword a0, v39, s[98:99]
  v_lshrrev_b32 v37, 4, v0
  v_and_b32 v38, 7, v0
  v_lshl_add_u32 v18, v37, 3, v38
  v_lshlrev_b32 v18, 10, v18
  s_and_b32 s92, s2, 7
  s_lshl_b32 s92, s92, 5
  s_lshr_b32 s86, s2, 3
  s_or_b32 s92, s92, s86
  s_lshl_b32 s86, s92, 2
  s_add_u32 s86, s86, 10485760
  s_mov_b32 s22, 254980
  s_mov_b32 s23, 0x20000
  s_mov_b32 s69, 0
  s_mov_b32 s70, 32
  s_mov_b32 s71, 1
  v_and_b32 v36, 31, v5
  v_lshlrev_b32 v17, 2, v36
  v_mov_b32 v40, 0
  v_mov_b32 v41, 0
  v_mov_b32 v42, 0
  v_mov_b32 v43, 0
  v_lshrrev_b32 v38, 5, v4
  v_mul_u32_u24 v38, 768, v38
  v_lshl_add_u32 v38, v36, 4, v38
  v_add_u32 v38, 85248, v38
  v_add_u32 v39, 49152, v38
  ds_write_b128 v38, v[40:43] offset:0
  ds_write_b128 v38, v[40:43] offset:12288
  ds_write_b128 v38, v[40:43] offset:24576
  ds_write_b128 v38, v[40:43] offset:36864
  ds_write_b128 v39, v[40:43] offset:0
  ds_write_b128 v39, v[40:43] offset:12288
  ds_write_b128 v39, v[40:43] offset:24576
  v_lshlrev_b32 v38, 4, v4
  ds_write_b128 v38, v[40:43] offset:0
  ds_write_b128 v38, v[40:43] offset:8192
  s_waitcnt lgkmcnt(0)
  s_add_u32 s20, s34, s86
  s_addc_u32 s21, s35, 0
  s_and_b32 s21, s21, 0xffff
  buffer_load_dword v23, v18, s[20:23], 0 offen
  s_mov_b32 s96, s34
  s_mov_b32 s97, s35
  s_mov_b32 s8, s4
  s_and_b32 s9, s5, 0xffff
  s_mov_b32 s10, 3200000
  s_mov_b32 s11, 0x20000
  s_mov_b32 s12, s30
  s_and_b32 s13, s31, 0xffff
  s_mov_b32 s14, 3200000
  s_mov_b32 s15, 0x20000
  s_mov_b32 s16, s34
  s_and_b32 s17, s35, 0xffff
  s_mov_b32 s18, 9600000
  s_mov_b32 s19, 0x20000
  s_add_u32 s24, s34, 10747904
  s_addc_u32 s25, s35, 0
  s_and_b32 s25, s25, 0xffff
  s_mov_b32 s26, 33792
  s_mov_b32 s27, 0x20000
  v_lshlrev_b32 v16, 4, v5
  s_lshl_b32 s86, s68, 12
  s_add_u32 s87, s86, 52224
  s_add_u32 s78, s86, 0
  s_cmp_lt_u32 s68, 4
  s_cselect_b32 m0, s87, s78
  s_mov_b32 s78, 32768
  buffer_load_dwordx4 v16, s[24:27], s86 offen lds
  buffer_load_dwordx4 v16, s[24:27], s86 offen offset:1024 lds
  buffer_load_dwordx4 v16, s[24:27], s86 offen offset:2048 lds
  buffer_load_dwordx4 v16, s[24:27], s86 offen offset:3072 lds
  buffer_load_dwordx2 v[28:29], v16, s[24:27], s78 offen
  buffer_load_dwordx2 v[32:33], v16, s[24:27], s78 offen offset:8
  v_lshrrev_b32 v38, 3, v5
  v_lshlrev_b32 v38, 15, v38
  v_and_b32 v39, 7, v5
  v_lshrrev_b32 v14, 4, v5
  v_xor_b32 v39, v39, v14
  v_lshl_add_u32 v14, v39, 4, v38
  v_xor_b32 v39, 4, v39
  v_lshl_add_u32 v16, v39, 4, v38
  s_lshl_b32 s86, s68, 19
  s_lshl_b32 s87, s92, 7
  s_add_u32 s86, s86, s87
  s_add_u32 s87, s86, 262144
  s_lshl_b32 s78, s68, 11
  s_add_u32 m0, s78, 68608
  s_nop 0
  buffer_load_dwordx4 v14, s[8:11], s86 offen lds
  s_add_u32 m0, s78, 69632
  s_nop 0
  buffer_load_dwordx4 v16, s[8:11], s87 offen lds
  s_mov_b32 s90, 0x05040100
  s_mov_b32 s91, 0x07060302
  s_mov_b32 s60, 0
  s_mov_b32 s61, 38400
  s_mov_b32 s62, 76800
  s_mov_b32 s63, 115200
  s_mov_b32 s64, 153600
  s_mov_b32 s65, 192000
  s_mov_b32 s66, 230400
  s_mov_b32 s67, 268800
  v_lshrrev_b32 v37, 5, v5
  v_lshlrev_b32 v19, 4, v37
  v_add_u32 v19, 50944, v19
  v_cmp_eq_u32 vcc, 0, v37
  v_mov_b32 v38, 0x3f80
  v_mov_b32 v39, 0
  v_cndmask_b32 v38, v39, v38, vcc
  v_accvgpr_write_b32 a68, v38
  v_accvgpr_write_b32 a69, v39
  v_mov_b32 v38, 128
  v_mov_b32 v39, 256
  v_cndmask_b32 v12, v38, v39, vcc
  v_lshlrev_b32 v38, 3, v36
  v_add_u32 v39, 32768, v17
  v_cndmask_b32 v13, v39, v38, vcc
  v_lshrrev_b32 v38, 3, v5
  v_lshlrev_b32 v15, 4, v38
  v_add_u32 v15, 32768, v15
  v_bfe_u32 v38, v36, 2, 1
  v_cmp_eq_u32 vcc, v38, v37
  v_bfe_u32 v38, v36, 3, 1
  v_lshlrev_b32 v38, 4, v38
  v_mov_b32 v39, 0x3f80
  v_lshlrev_b32 v39, v38, v39
  v_cndmask_b32 v39, 0, v39, vcc
  v_cmp_gt_u32 vcc, 16, v36
  s_nop 1
  v_cndmask_b32 v38, 0, v39, vcc
  v_cndmask_b32 v39, v39, 0, vcc
  v_accvgpr_write_b32 a66, v38
  v_accvgpr_write_b32 a67, v39
  v_and_b32 v38, 7, v5
  v_bfe_u32 v39, v5, 4, 1
  v_lshlrev_b32 v39, 2, v39
  v_xor_b32 v38, v38, v39
  v_xor_b32 v8, 0, v38
  v_lshlrev_b32 v8, 4, v8
  v_xor_b32 v9, 1, v38
  v_lshlrev_b32 v9, 4, v9
  v_xor_b32 v10, 2, v38
  v_lshlrev_b32 v10, 4, v10
  v_xor_b32 v11, 3, v38
  v_lshlrev_b32 v11, 4, v11
  v_bfe_u32 v38, v36, 1, 3
  v_lshlrev_b32 v39, 2, v37
  v_xor_b32 v38, v38, v39
  v_lshlrev_b32 v39, 7, v36
  v_add_u32 v39, 68608, v39
  v_xor_b32 v24, 0, v38
  v_lshl_add_u32 v24, v24, 4, v39
  v_xor_b32 v25, 1, v38
  v_lshl_add_u32 v25, v25, 4, v39
  v_xor_b32 v26, 2, v38
  v_lshl_add_u32 v26, v26, 4, v39
  v_xor_b32 v27, 3, v38
  v_lshl_add_u32 v27, v27, 4, v39
  s_lshl_b32 s84, s68, 12
  s_add_u32 s84, s84, 52224
  v_mul_u32_u24 v7, 3072, v37
  v_add_u32 v7, v7, v17
  v_and_b32 v38, 3, v36
  v_bfe_u32 v16, v36, 3, 1
  v_xor_b32 v16, v16, v37
  v_lshl_or_b32 v16, v16, 2, v38
  v_lshlrev_b32 v38, 10, v38
  v_lshrrev_b32 v36, 2, v36
  v_lshl_add_u32 v38, v36, 7, v38
  v_add_u32 v38, s84, v38
  v_xor_b32 v0, 0, v16
  v_lshl_add_u32 v0, v0, 4, v38
  v_xor_b32 v1, 1, v16
  v_lshl_add_u32 v1, v1, 4, v38
  v_xor_b32 v2, 2, v16
  v_lshl_add_u32 v2, v2, 4, v38
  v_xor_b32 v3, 3, v16
  v_lshl_add_u32 v3, v3, 4, v38
K2_RESET:
  v_mov_b32 v40, 0
  v_mov_b32 v41, 0
  v_mov_b32 v42, 0
  v_mov_b32 v43, 0
  v_mov_b32 v44, 1.0
  v_mov_b32 v45, 1.0
  v_mov_b32 v46, 1.0
  v_mov_b32 v47, 1.0
  v_mov_b32 v6, 1
  v_lshlrev_b32 v38, 4, v4
  ds_write_b128 v38, v[44:47] offset:32768
  ds_write_b128 v38, v[44:47] offset:40960
  v_cmp_gt_u32 vcc, 156, v4
  s_and_saveexec_b64 s[94:95], vcc
  ds_write_b128 v38, v[40:43] offset:49152
  s_mov_b64 exec, s[94:95]
  v_and_b32 v36, 15, v4
  v_add_u32 v37, 16, v36
  v_mov_b32 v39, 0xffff
  v_cmp_gt_u32 vcc, s70, v36
  v_add_u32 v38, s69, v36
  s_nop 0
  v_cndmask_b32 v20, v39, v38, vcc
  v_cmp_gt_u32 vcc, s70, v37
  v_add_u32 v37, s69, v37
  s_nop 0
  v_cndmask_b32 v21, v39, v37, vcc
  v_mul_u32_u24 v38, 12, v38
  v_lshrrev_b32 v37, 4, v4
  s_mov_b32 s86, 307200
  v_mad_u32_u24 v22, v37, s86, v38
  s_cmp_eq_u32 s71, 1
  s_cbranch_scc1 K2_OFW
  v_and_b32 v38, 7, v4
  v_lshl_add_u32 v38, v37, 3, v38
  v_lshlrev_b32 v38, 10, v38
  buffer_load_dword v23, v38, s[20:23], 0 offen
  s_waitcnt vmcnt(0)
K2_OFW:
  s_waitcnt vmcnt(8)
  v_mov_b32_dpp v120, v23 row_newbcast:0 row_mask:0xf bank_mask:0xf
  v_mov_b32_dpp v121, v23 row_newbcast:1 row_mask:0xf bank_mask:0xf
  v_mov_b32_dpp v122, v23 row_newbcast:2 row_mask:0xf bank_mask:0xf
  v_mov_b32_dpp v123, v23 row_newbcast:3 row_mask:0xf bank_mask:0xf
  v_mov_b32_dpp v124, v23 row_newbcast:4 row_mask:0xf bank_mask:0xf
  v_mov_b32_dpp v125, v23 row_newbcast:5 row_mask:0xf bank_mask:0xf
  v_mov_b32_dpp v126, v23 row_newbcast:6 row_mask:0xf bank_mask:0xf
  v_mov_b32_dpp v127, v23 row_newbcast:7 row_mask:0xf bank_mask:0xf
  v_add_u32_sdwa v128, v120, v22 dst_sel:DWORD dst_unused:UNUSED_PAD src0_sel:WORD_0 src1_sel:DWORD
  v_cmp_lt_u32_sdwa s[28:29], v20, v120 src0_sel:DWORD src1_sel:WORD_1
  s_mov_b64 exec, s[28:29]
  buffer_load_dwordx3 v[40:42], v128, s[16:19], s60 offen
  s_mov_b64 exec, -1
  v_add_u32_sdwa v129, v121, v22 dst_sel:DWORD dst_unused:UNUSED_PAD src0_sel:WORD_0 src1_sel:DWORD
  v_cmp_lt_u32_sdwa s[30:31], v20, v121 src0_sel:DWORD src1_sel:WORD_1
  s_mov_b64 exec, s[30:31]
  buffer_load_dwordx3 v[44:46], v129, s[16:19], s61 offen
  s_mov_b64 exec, -1
  v_add_u32_sdwa v130, v122, v22 dst_sel:DWORD dst_unused:UNUSED_PAD src0_sel:WORD_0 src1_sel:DWORD
  v_cmp_lt_u32_sdwa s[32:33], v20, v122 src0_sel:DWORD src1_sel:WORD_1
  s_mov_b64 exec, s[32:33]
  buffer_load_dwordx3 v[48:50], v130, s[16:19], s62 offen
  s_mov_b64 exec, -1
  v_add_u32_sdwa v131, v123, v22 dst_sel:DWORD dst_unused:UNUSED_PAD src0_sel:WORD_0 src1_sel:DWORD
  v_cmp_lt_u32_sdwa s[34:35], v20, v123 src0_sel:DWORD src1_sel:WORD_1
  s_mov_b64 exec, s[34:35]
  buffer_load_dwordx3 v[52:54], v131, s[16:19], s63 offen
  s_mov_b64 exec, -1
  v_add_u32_sdwa v132, v124, v22 dst_sel:DWORD dst_unused:UNUSED_PAD src0_sel:WORD_0 src1_sel:DWORD
  v_cmp_lt_u32_sdwa s[36:37], v20, v124 src0_sel:DWORD src1_sel:WORD_1
  s_mov_b64 exec, s[36:37]
  buffer_load_dwordx3 v[56:58], v132, s[16:19], s64 offen
  s_mov_b64 exec, -1
  v_add_u32_sdwa v133, v125, v22 dst_sel:DWORD dst_unused:UNUSED_PAD src0_sel:WORD_0 src1_sel:DWORD
  v_cmp_lt_u32_sdwa s[38:39], v20, v125 src0_sel:DWORD src1_sel:WORD_1
  s_mov_b64 exec, s[38:39]
  buffer_load_dwordx3 v[60:62], v133, s[16:19], s65 offen
  s_mov_b64 exec, -1
  v_add_u32_sdwa v134, v126, v22 dst_sel:DWORD dst_unused:UNUSED_PAD src0_sel:WORD_0 src1_sel:DWORD
  v_cmp_lt_u32_sdwa s[40:41], v20, v126 src0_sel:DWORD src1_sel:WORD_1
  s_mov_b64 exec, s[40:41]
  buffer_load_dwordx3 v[64:66], v134, s[16:19], s66 offen
  s_mov_b64 exec, -1
  v_add_u32_sdwa v135, v127, v22 dst_sel:DWORD dst_unused:UNUSED_PAD src0_sel:WORD_0 src1_sel:DWORD
  v_cmp_lt_u32_sdwa s[42:43], v20, v127 src0_sel:DWORD src1_sel:WORD_1
  s_mov_b64 exec, s[42:43]
  buffer_load_dwordx3 v[68:70], v135, s[16:19], s67 offen
  s_mov_b64 exec, -1
  s_mov_b32 s78, 0
  v_cmp_lt_u32_sdwa s[44:45], v21, v120 src0_sel:DWORD src1_sel:WORD_1
  v_cmp_lt_u32_sdwa s[46:47], v21, v121 src0_sel:DWORD src1_sel:WORD_1
  v_cmp_lt_u32_sdwa s[48:49], v21, v122 src0_sel:DWORD src1_sel:WORD_1
  v_cmp_lt_u32_sdwa s[50:51], v21, v123 src0_sel:DWORD src1_sel:WORD_1
  v_cmp_lt_u32_sdwa s[52:53], v21, v124 src0_sel:DWORD src1_sel:WORD_1
  v_cmp_lt_u32_sdwa s[54:55], v21, v125 src0_sel:DWORD src1_sel:WORD_1
  v_cmp_lt_u32_sdwa s[56:57], v21, v126 src0_sel:DWORD src1_sel:WORD_1
  v_cmp_lt_u32_sdwa s[58:59], v21, v127 src0_sel:DWORD src1_sel:WORD_1
  s_mov_b64 exec, s[44:45]
  s_cbranch_execz K2_LS0
  s_add_u32 s78, s78, 1
  buffer_load_dwordx3 v[72:74], v128, s[16:19], s60 offen offset:192
K2_LS0:
  s_mov_b64 exec, s[46:47]
  s_cbranch_execz K2_LS1
  s_add_u32 s78, s78, 1
  buffer_load_dwordx3 v[76:78], v129, s[16:19], s61 offen offset:192
K2_LS1:
  s_mov_b64 exec, s[48:49]
  s_cbranch_execz K2_LS2
  s_add_u32 s78, s78, 1
  buffer_load_dwordx3 v[80:82], v130, s[16:19], s62 offen offset:192
K2_LS2:
  s_mov_b64 exec, s[50:51]
  s_cbranch_execz K2_LS3
  s_add_u32 s78, s78, 1
  buffer_load_dwordx3 v[84:86], v131, s[16:19], s63 offen offset:192
K2_LS3:
  s_mov_b64 exec, s[52:53]
  s_cbranch_execz K2_LS4
  s_add_u32 s78, s78, 1
  buffer_load_dwordx3 v[88:90], v132, s[16:19], s64 offen offset:192
K2_LS4:
  s_mov_b64 exec, s[54:55]
  s_cbranch_execz K2_LS5
  s_add_u32 s78, s78, 1
  buffer_load_dwordx3 v[92:94], v133, s[16:19], s65 offen offset:192
K2_LS5:
  s_mov_b64 exec, s[56:57]
  s_cbranch_execz K2_LS6
  s_add_u32 s78, s78, 1
  buffer_load_dwordx3 v[96:98], v134, s[16:19], s66 offen offset:192
K2_LS6:
  s_mov_b64 exec, s[58:59]
  s_cbranch_execz K2_LS7
  s_add_u32 s78, s78, 1
  buffer_load_dwordx3 v[100:102], v135, s[16:19], s67 offen offset:192
K2_LS7:
  s_mov_b64 exec, -1
  v_max3_u32 v38, v120, v121, v122
  v_max3_u32 v39, v123, v124, v125
  v_max3_u32 v38, v126, v127, v38
  v_max_u32 v38, v38, v39
  v_lshrrev_b32 v23, 16, v38
  v_mov_b32 v38, 51584
  s_mov_b32 s94, 0x00010001
  s_mov_b32 s95, 0x00010001
  v_lshlrev_b32 v16, 4, v5
  v_add_u32 v14, 52224, v16
  s_cmp_lg_u32 s78, 0
  s_cbranch_scc1 K2_IW0
  s_waitcnt vmcnt(8)
  s_branch K2_IWD
K2_IW0:
  s_cmp_lg_u32 s78, 1
  s_cbranch_scc1 K2_IW1
  s_waitcnt vmcnt(9)
  s_branch K2_IWD
K2_IW1:
  s_cmp_lg_u32 s78, 2
  s_cbranch_scc1 K2_IW2
  s_waitcnt vmcnt(10)
  s_branch K2_IWD
K2_IW2:
  s_cmp_lg_u32 s78, 3
  s_cbranch_scc1 K2_IW3
  s_waitcnt vmcnt(11)
  s_branch K2_IWD
K2_IW3:
  s_cmp_lg_u32 s78, 4
  s_cbranch_scc1 K2_IW4
  s_waitcnt vmcnt(12)
  s_branch K2_IWD
K2_IW4:
  s_cmp_lg_u32 s78, 5
  s_cbranch_scc1 K2_IW5
  s_waitcnt vmcnt(13)
  s_branch K2_IWD
K2_IW5:
  s_cmp_lg_u32 s78, 6
  s_cbranch_scc1 K2_IW6
  s_waitcnt vmcnt(14)
  s_branch K2_IWD
K2_IW6:
  s_cmp_lg_u32 s78, 7
  s_cbranch_scc1 K2_IW7
  s_waitcnt vmcnt(15)
  s_branch K2_IWD
K2_IW7:
  s_cmp_lg_u32 s78, 8
  s_cbranch_scc1 K2_IW8
  s_waitcnt vmcnt(16)
  s_branch K2_IWD
K2_IW8:
K2_IWD:
  s_waitcnt lgkmcnt(0)
  s_barrier
  s_mov_b64 exec, s[94:95]
  ds_max_u32 v38, v23
  s_mov_b64 exec, -1
  s_cmp_eq_u32 s71, 0
  s_cbranch_scc1 K2_RANK
  s_lshr_b32 s86, s68, 1
  s_lshl_b32 s87, s86, 12
  s_mul_i32 s86, s86, 24576
  v_add_u32 v36, s87, v24
  v_add_u32 v37, s87, v25
  v_add_u32 v38, s87, v26
  v_add_u32 v39, s87, v27
  ds_read_b128 a[86:89], v36
  ds_read_b128 a[90:93], v37
  ds_read_b128 a[94:97], v38
  ds_read_b128 a[98:101], v39
  s_mov_b32 s88, 0xbfb8aa3b
  s_and_b32 s87, s68, 1
  s_cselect_b32 s88, 1.0, s88
  s_lshl_b32 s78, s87, 13
  s_add_u32 s78, s78, 16384
  v_add_u32 v36, s78, v16
  s_lshl_b32 s87, s87, 7
  s_add_u32 s86, s86, s87
  s_add_u32 s86, s86, 84992
  v_add_u32 v37, s86, v7
  ds_read_b128 a[0:3], v36 offset:0
  ds_read_b128 a[4:7], v36 offset:1024
  ds_read_b128 a[8:11], v36 offset:2048
  ds_read_b128 a[12:15], v36 offset:3072
  ds_read_b128 a[16:19], v36 offset:4096
  ds_read_b128 a[20:23], v36 offset:5120
  ds_read_b128 a[24:27], v36 offset:6144
  ds_read_b128 a[28:31], v36 offset:7168
  s_waitcnt lgkmcnt(7)
  v_mfma_f32_32x32x16_bf16 v[120:135], a[86:89], a[0:3], 0
  s_waitcnt lgkmcnt(6)
  v_mfma_f32_32x32x16_bf16 v[136:151], a[86:89], a[4:7], 0
  s_waitcnt lgkmcnt(5)
  v_mfma_f32_32x32x16_bf16 v[120:135], a[90:93], a[8:11], v[120:135]
  s_waitcnt lgkmcnt(4)
  v_mfma_f32_32x32x16_bf16 v[136:151], a[90:93], a[12:15], v[136:151]
  s_waitcnt lgkmcnt(3)
  v_mfma_f32_32x32x16_bf16 v[120:135], a[94:97], a[16:19], v[120:135]
  s_waitcnt lgkmcnt(2)
  v_mfma_f32_32x32x16_bf16 v[136:151], a[94:97], a[20:23], v[136:151]
  s_waitcnt lgkmcnt(1)
  v_mfma_f32_32x32x16_bf16 v[120:135], a[98:101], a[24:27], v[120:135]
  s_waitcnt lgkmcnt(0)
  v_mfma_f32_32x32x16_bf16 v[136:151], a[98:101], a[28:31], v[136:151]
  ds_read_b128 a[32:35], v14 offset:8192
  ds_read_b128 a[36:39], v14 offset:9216
  ds_read_b128 a[40:43], v14 offset:10240
  ds_read_b128 a[44:47], v14 offset:11264
  ds_read_b128 a[48:51], v14 offset:12288
  ds_read_b128 a[52:55], v14 offset:13312
  ds_read_b128 a[56:59], v14 offset:14336
  ds_read_b128 a[60:63], v14 offset:15360
  s_nop 3
  v_mul_f32 v120, s88, v120
  v_mul_f32 v136, s88, v136
  v_cvt_pk_bf16_f32 v120, v120, v136
  ds_write_b32 v37, v120 offset:0
  v_mul_f32 v121, s88, v121
  v_mul_f32 v137, s88, v137
  v_cvt_pk_bf16_f32 v121, v121, v137
  ds_write_b32 v37, v121 offset:768
  v_mul_f32 v122, s88, v122
  v_mul_f32 v138, s88, v138
  v_cvt_pk_bf16_f32 v122, v122, v138
  ds_write_b32 v37, v122 offset:1536
  s_cmp_ge_u32 s68, 6
  s_cbranch_scc1 K2_JOBE
  v_mul_f32 v123, s88, v123
  v_mul_f32 v139, s88, v139
  v_cvt_pk_bf16_f32 v123, v123, v139
  ds_write_b32 v37, v123 offset:2304
  v_mul_f32 v124, s88, v124
  v_mul_f32 v140, s88, v140
  v_cvt_pk_bf16_f32 v124, v124, v140
  ds_write_b32 v37, v124 offset:6144
  v_mul_f32 v125, s88, v125
  v_mul_f32 v141, s88, v141
  v_cvt_pk_bf16_f32 v125, v125, v141
  ds_write_b32 v37, v125 offset:6912
  v_mul_f32 v126, s88, v126
  v_mul_f32 v142, s88, v142
  v_cvt_pk_bf16_f32 v126, v126, v142
  ds_write_b32 v37, v126 offset:7680
  v_mul_f32 v127, s88, v127
  v_mul_f32 v143, s88, v143
  v_cvt_pk_bf16_f32 v127, v127, v143
  ds_write_b32 v37, v127 offset:8448
  v_mul_f32 v128, s88, v128
  v_mul_f32 v144, s88, v144
  v_cvt_pk_bf16_f32 v128, v128, v144
  ds_write_b32 v37, v128 offset:12288
  v_mul_f32 v129, s88, v129
  v_mul_f32 v145, s88, v145
  v_cvt_pk_bf16_f32 v129, v129, v145
  ds_write_b32 v37, v129 offset:13056
  v_mul_f32 v130, s88, v130
  v_mul_f32 v146, s88, v146
  v_cvt_pk_bf16_f32 v130, v130, v146
  ds_write_b32 v37, v130 offset:13824
  v_mul_f32 v131, s88, v131
  v_mul_f32 v147, s88, v147
  v_cvt_pk_bf16_f32 v131, v131, v147
  ds_write_b32 v37, v131 offset:14592
  v_mul_f32 v132, s88, v132
  v_mul_f32 v148, s88, v148
  v_cvt_pk_bf16_f32 v132, v132, v148
  ds_write_b32 v37, v132 offset:18432
  v_mul_f32 v133, s88, v133
  v_mul_f32 v149, s88, v149
  v_cvt_pk_bf16_f32 v133, v133, v149
  ds_write_b32 v37, v133 offset:19200
  v_mul_f32 v134, s88, v134
  v_mul_f32 v150, s88, v150
  v_cvt_pk_bf16_f32 v134, v134, v150
  ds_write_b32 v37, v134 offset:19968
  v_mul_f32 v135, s88, v135
  v_mul_f32 v151, s88, v151
  v_cvt_pk_bf16_f32 v135, v135, v151
  ds_write_b32 v37, v135 offset:20736
K2_JOBE:
  ds_read_b128 a[0:3], v14 offset:0
  ds_read_b128 a[4:7], v14 offset:1024
  ds_read_b128 a[8:11], v14 offset:2048
  ds_read_b128 a[12:15], v14 offset:3072
  ds_read_b128 a[16:19], v14 offset:4096
  ds_read_b128 a[20:23], v14 offset:5120
  ds_read_b128 a[24:27], v14 offset:6144
  ds_read_b128 a[28:31], v14 offset:7168
K2_RANK:
  s_waitcnt vmcnt(0)
  s_mov_b64 exec, s[28:29]
  v_lshrrev_b32 v104, 16, v42
  ds_add_rtn_u32 v43, v104, v6 offset:49152
  s_mov_b64 exec, s[30:31]
  v_lshrrev_b32 v105, 16, v46
  ds_add_rtn_u32 v47, v105, v6 offset:49152
  s_mov_b64 exec, s[32:33]
  v_lshrrev_b32 v106, 16, v50
  ds_add_rtn_u32 v51, v106, v6 offset:49152
  s_mov_b64 exec, s[34:35]
  v_lshrrev_b32 v107, 16, v54
  ds_add_rtn_u32 v55, v107, v6 offset:49152
  s_mov_b64 exec, s[36:37]
  v_lshrrev_b32 v108, 16, v58
  ds_add_rtn_u32 v59, v108, v6 offset:49152
  s_mov_b64 exec, s[38:39]
  v_lshrrev_b32 v109, 16, v62
  ds_add_rtn_u32 v63, v109, v6 offset:49152
  s_mov_b64 exec, s[40:41]
  v_lshrrev_b32 v110, 16, v66
  ds_add_rtn_u32 v67, v110, v6 offset:49152
  s_mov_b64 exec, s[42:43]
  v_lshrrev_b32 v111, 16, v70
  ds_add_rtn_u32 v71, v111, v6 offset:49152
  s_mov_b64 exec, s[44:45]
  s_cbranch_execz K2_RS8
  v_lshrrev_b32 v112, 16, v74
  ds_add_rtn_u32 v75, v112, v6 offset:49152
K2_RS8:
  s_mov_b64 exec, s[46:47]
  s_cbranch_execz K2_RS9
  v_lshrrev_b32 v113, 16, v78
  ds_add_rtn_u32 v79, v113, v6 offset:49152
K2_RS9:
  s_mov_b64 exec, s[48:49]
  s_cbranch_execz K2_RS10
  v_lshrrev_b32 v114, 16, v82
  ds_add_rtn_u32 v83, v114, v6 offset:49152
K2_RS10:
  s_mov_b64 exec, s[50:51]
  s_cbranch_execz K2_RS11
  v_lshrrev_b32 v115, 16, v86
  ds_add_rtn_u32 v87, v115, v6 offset:49152
K2_RS11:
  s_mov_b64 exec, s[52:53]
  s_cbranch_execz K2_RS12
  v_lshrrev_b32 v116, 16, v90
  ds_add_rtn_u32 v91, v116, v6 offset:49152
K2_RS12:
  s_mov_b64 exec, s[54:55]
  s_cbranch_execz K2_RS13
  v_lshrrev_b32 v117, 16, v94
  ds_add_rtn_u32 v95, v117, v6 offset:49152
K2_RS13:
  s_mov_b64 exec, s[56:57]
  s_cbranch_execz K2_RS14
  v_lshrrev_b32 v118, 16, v98
  ds_add_rtn_u32 v99, v118, v6 offset:49152
K2_RS14:
  s_mov_b64 exec, s[58:59]
  s_cbranch_execz K2_RS15
  v_lshrrev_b32 v119, 16, v102
  ds_add_rtn_u32 v103, v119, v6 offset:49152
K2_RS15:
  s_mov_b64 exec, -1
  s_waitcnt lgkmcnt(0)
  s_barrier
  s_cmp_lg_u32 s68, 0
  s_cbranch_scc1 K2_PRE
  v_lshlrev_b32 v38, 2, v5
  ds_read2st64_b32 v[120:121], v38 offset0:192 offset1:193
  s_waitcnt lgkmcnt(0)
  v_add_u32 v122, 3, v120
  v_add_u32 v123, 3, v121
  v_lshrrev_b32 v122, 2, v122
  v_lshrrev_b32 v123, 2, v123
  v_min_u32 v124, 63, v122
  v_min_u32 v125, 63, v123
  v_sub_u32 v124, 63, v124
  v_sub_u32 v125, 63, v125
  v_lshlrev_b32 v124, 2, v124
  v_lshlrev_b32 v125, 2, v125
  ds_add_rtn_u32 v126, v124, v6 offset:50176
  ds_add_rtn_u32 v127, v125, v6 offset:50176
  ds_read_b32 v128, v38 offset:50176
  v_lshl_or_b32 v122, v122, 8, v5
  v_add_u32 v37, 64, v5
  v_lshl_or_b32 v123, v123, 8, v37
  s_waitcnt lgkmcnt(0)
  v_mov_b32 v129, v128
  s_nop 1
  v_add_u32_dpp v129, v129, v129 row_shr:1 row_mask:0xf bank_mask:0xf
  s_nop 1
  v_add_u32_dpp v129, v129, v129 row_shr:2 row_mask:0xf bank_mask:0xf
  s_nop 1
  v_add_u32_dpp v129, v129, v129 row_shr:4 row_mask:0xf bank_mask:0xf
  s_nop 1
  v_add_u32_dpp v129, v129, v129 row_shr:8 row_mask:0xf bank_mask:0xf
  s_nop 1
  v_add_u32_dpp v129, v129, v129 row_bcast:15 row_mask:0xa bank_mask:0xf
  s_nop 1
  v_add_u32_dpp v129, v129, v129 row_bcast:31 row_mask:0xc bank_mask:0xf
  v_sub_u32 v129, v129, v128
  ds_bpermute_b32 v36, v124, v129
  ds_bpermute_b32 v37, v125, v129
  v_cmp_gt_u32 vcc, 8, v5
  v_subrev_u32 v120, 24, v38
  v_and_b32 v121, 4, v5
  s_mov_b32 s87, 0xff
  v_cndmask_b32 v120, v120, v121, vcc
  s_waitcnt lgkmcnt(0)
  v_add_lshl_u32 v36, v36, v126, 2
  v_add_lshl_u32 v37, v37, v127, 2
  ds_write_b32 v36, v122 offset:50432
  ds_write_b32 v37, v123 offset:50432
  ds_read_b32 v130, v120 offset:50432
  ds_read_b32 v131, v38 offset:50664
  s_waitcnt lgkmcnt(0)
  v_add_u32 v120, 0x300, v130
  v_lshrrev_b32 v120, 2, v120
  v_bfi_b32 v120, s87, v130, v120
  v_cndmask_b32 v130, v130, v120, vcc
  v_mov_b32 v132, v130
  v_mov_b32 v133, v131
  s_nop 0
  v_max_u32_dpp v132, v132, v132 quad_perm:[1,0,3,2] row_mask:0xf bank_mask:0xf
  v_max_u32_dpp v133, v133, v133 quad_perm:[1,0,3,2] row_mask:0xf bank_mask:0xf
  s_nop 0
  v_max_u32_dpp v132, v132, v132 quad_perm:[2,3,0,1] row_mask:0xf bank_mask:0xf
  v_max_u32_dpp v133, v133, v133 quad_perm:[2,3,0,1] row_mask:0xf bank_mask:0xf
  s_nop 0
  v_max_u32_dpp v132, v132, v132 row_half_mirror row_mask:0xf bank_mask:0xf
  v_max_u32_dpp v133, v133, v133 row_half_mirror row_mask:0xf bank_mask:0xf
  v_lshrrev_b32 v132, 8, v132
  v_lshrrev_b32 v133, 8, v133
  v_mov_b32 v134, v132
  v_mov_b32 v135, v133
  s_nop 0
  v_add_u32_dpp v134, v134, v134 row_shr:8 row_mask:0xf bank_mask:0xf
  v_add_u32_dpp v135, v135, v135 row_shr:8 row_mask:0xf bank_mask:0xf
  s_nop 0
  v_add_u32_dpp v134, v134, v134 row_bcast:15 row_mask:0xa bank_mask:0xf
  v_add_u32_dpp v135, v135, v135 row_bcast:15 row_mask:0xa bank_mask:0xf
  s_nop 0
  v_add_u32_dpp v134, v134, v134 row_bcast:31 row_mask:0xc bank_mask:0xf
  v_add_u32_dpp v135, v135, v135 row_bcast:31 row_mask:0xc bank_mask:0xf
  s_nop 0
  v_readlane_b32 s86, v134, 63
  v_sub_u32 v134, v134, v132
  v_sub_u32 v133, v135, v133
  v_add_u32 v135, s86, v135
  v_add_u32 v133, s86, v133
  v_and_b32 v36, 7, v5
  v_lshl_or_b32 v37, v36, 5, 2
  v_lshl_or_b32 v36, v121, 5, 4
  v_cndmask_b32 v36, v37, v36, vcc
  v_lshl_add_u32 v126, v134, 8, v36
  v_lshl_add_u32 v127, v133, 8, v37
  v_and_b32 v130, 0xff, v130
  v_and_b32 v131, 0xff, v131
  v_lshlrev_b32 v120, 2, v130
  v_lshlrev_b32 v121, 2, v131
  ds_write_b32 v120, v126 offset:49664
  ds_write_b32 v121, v127 offset:49664
  v_lshrrev_b32 v36, 1, v5
  v_add_u32 v36, 51456, v36
  s_mov_b32 s94, 0x01010101
  s_mov_b32 s95, 0x01010101
  s_mov_b64 exec, s[94:95]
  ds_write2_b32 v36, v134, v133 offset0:0 offset1:8
  s_mov_b32 s94, 0
  s_mov_b32 s95, 0x80000000
  s_mov_b64 exec, s[94:95]
  v_mov_b32 v37, 51520
  ds_write2_b32 v37, v135, v128 offset0:0 offset1:1
  s_mov_b64 exec, -1
  v_min_u32 v130, 98, v130
  v_min_u32 v131, 98, v131
  v_mov_b32 v120, 84992
  s_mov_b32 s86, 768
  v_mad_u32_u24 v130, v130, s86, v120
  v_mad_u32_u24 v131, v131, s86, v120
  v_and_b32 v120, 1, v5
  v_lshlrev_b32 v120, 4, v120
  v_bfe_u32 v121, v5, 1, 2
  v_lshl_add_u32 v120, v121, 2, v120
  v_and_b32 v121, 56, v5
  v_lshl_add_u32 v120, v121, 2, v120
  v_add_u32 v120, 50944, v120
  ds_write2st64_b32 v120, v130, v131 offset0:0 offset1:1
K2_PRE:
  s_mov_b32 s86, -28
  v_and_b32 v42, 0x7fff, v42
  v_and_b32 v46, 0x7fff, v46
  v_and_b32 v50, 0x7fff, v50
  v_and_b32 v54, 0x7fff, v54
  v_and_b32 v58, 0x7fff, v58
  v_and_b32 v62, 0x7fff, v62
  v_and_b32 v66, 0x7fff, v66
  v_and_b32 v70, 0x7fff, v70
  v_and_b32 v74, 0x7fff, v74
  v_and_b32 v78, 0x7fff, v78
  v_and_b32 v82, 0x7fff, v82
  v_and_b32 v86, 0x7fff, v86
  v_and_b32 v90, 0x7fff, v90
  v_and_b32 v94, 0x7fff, v94
  v_and_b32 v98, 0x7fff, v98
  v_and_b32 v102, 0x7fff, v102
  v_min_u32 v36, 17, v5
  v_lshlrev_b32 v36, 2, v36
  v_mov_b32 v37, 51584
  s_waitcnt lgkmcnt(0)
  s_barrier
  ds_read_b32 v18, v36 offset:51456
  ds_read_b32 v38, v37
  s_mov_b64 exec, s[28:29]
  ds_read_b32 v104, v104 offset:49664
  s_mov_b64 exec, s[30:31]
  ds_read_b32 v105, v105 offset:49664
  s_mov_b64 exec, s[32:33]
  ds_read_b32 v106, v106 offset:49664
  s_mov_b64 exec, s[34:35]
  ds_read_b32 v107, v107 offset:49664
  s_mov_b64 exec, s[36:37]
  ds_read_b32 v108, v108 offset:49664
  s_mov_b64 exec, s[38:39]
  ds_read_b32 v109, v109 offset:49664
  s_mov_b64 exec, s[40:41]
  ds_read_b32 v110, v110 offset:49664
  s_mov_b64 exec, s[42:43]
  ds_read_b32 v111, v111 offset:49664
  s_mov_b64 exec, -1
  s_waitcnt lgkmcnt(8)
  v_readlane_b32 s72, v18, 16
  v_readfirstlane_b32 s85, v38
  s_cmp_le_u32 s72, 128
  s_cbranch_scc1 K2_FIT
  s_cmp_le_u32 s70, 1
  s_cbranch_scc1 K2_END
  s_lshr_b32 s70, s70, 1
  s_mov_b32 s71, 0
  s_waitcnt lgkmcnt(0) vmcnt(0)
  s_barrier
  s_branch K2_RESET
K2_FIT:
  s_mov_b64 exec, s[44:45]
  s_cbranch_execz K2_NS8
  ds_read_b32 v112, v112 offset:49664
K2_NS8:
  s_mov_b64 exec, s[46:47]
  s_cbranch_execz K2_NS9
  ds_read_b32 v113, v113 offset:49664
K2_NS9:
  s_mov_b64 exec, s[48:49]
  s_cbranch_execz K2_NS10
  ds_read_b32 v114, v114 offset:49664
K2_NS10:
  s_mov_b64 exec, s[50:51]
  s_cbranch_execz K2_NS11
  ds_read_b32 v115, v115 offset:49664
K2_NS11:
  s_mov_b64 exec, s[52:53]
  s_cbranch_execz K2_NS12
  ds_read_b32 v116, v116 offset:49664
K2_NS12:
  s_mov_b64 exec, s[54:55]
  s_cbranch_execz K2_NS13
  ds_read_b32 v117, v117 offset:49664
K2_NS13:
  s_mov_b64 exec, s[56:57]
  s_cbranch_execz K2_NS14
  ds_read_b32 v118, v118 offset:49664
K2_NS14:
  s_mov_b64 exec, s[58:59]
  s_cbranch_execz K2_NS15
  ds_read_b32 v119, v119 offset:49664
K2_NS15:
  s_waitcnt lgkmcnt(0)
  s_mov_b64 exec, s[28:29]
  v_lshrrev_b32 v36, v104, v43
  v_bfe_u32 v43, v43, 0, v104
  v_lshl_add_u32 v36, v36, 8, v104
  v_lshl_add_u32 v36, v43, 3, v36
  v_and_b32 v43, -8, v36
  v_lshrrev_b32 v104, 1, v43
  ds_write_b32 v104, v42 offset:32768
  s_mov_b64 exec, s[30:31]
  v_lshrrev_b32 v36, v105, v47
  v_bfe_u32 v47, v47, 0, v105
  v_lshl_add_u32 v36, v36, 8, v105
  v_lshl_add_u32 v36, v47, 3, v36
  v_and_b32 v47, -8, v36
  v_lshrrev_b32 v105, 1, v47
  ds_write_b32 v105, v46 offset:32768
  s_mov_b64 exec, s[32:33]
  v_lshrrev_b32 v36, v106, v51
  v_bfe_u32 v51, v51, 0, v106
  v_lshl_add_u32 v36, v36, 8, v106
  v_lshl_add_u32 v36, v51, 3, v36
  v_and_b32 v51, -8, v36
  v_lshrrev_b32 v106, 1, v51
  ds_write_b32 v106, v50 offset:32768
  s_mov_b64 exec, s[34:35]
  v_lshrrev_b32 v36, v107, v55
  v_bfe_u32 v55, v55, 0, v107
  v_lshl_add_u32 v36, v36, 8, v107
  v_lshl_add_u32 v36, v55, 3, v36
  v_and_b32 v55, -8, v36
  v_lshrrev_b32 v107, 1, v55
  ds_write_b32 v107, v54 offset:32768
  s_mov_b64 exec, s[36:37]
  v_lshrrev_b32 v36, v108, v59
  v_bfe_u32 v59, v59, 0, v108
  v_lshl_add_u32 v36, v36, 8, v108
  v_lshl_add_u32 v36, v59, 3, v36
  v_and_b32 v59, -8, v36
  v_lshrrev_b32 v108, 1, v59
  ds_write_b32 v108, v58 offset:32768
  s_mov_b64 exec, s[38:39]
  v_lshrrev_b32 v36, v109, v63
  v_bfe_u32 v63, v63, 0, v109
  v_lshl_add_u32 v36, v36, 8, v109
  v_lshl_add_u32 v36, v63, 3, v36
  v_and_b32 v63, -8, v36
  v_lshrrev_b32 v109, 1, v63
  ds_write_b32 v109, v62 offset:32768
  s_mov_b64 exec, s[40:41]
  v_lshrrev_b32 v36, v110, v67
  v_bfe_u32 v67, v67, 0, v110
  v_lshl_add_u32 v36, v36, 8, v110
  v_lshl_add_u32 v36, v67, 3, v36
  v_and_b32 v67, -8, v36
  v_lshrrev_b32 v110, 1, v67
  ds_write_b32 v110, v66 offset:32768
  s_mov_b64 exec, s[42:43]
  v_lshrrev_b32 v36, v111, v71
  v_bfe_u32 v71, v71, 0, v111
  v_lshl_add_u32 v36, v36, 8, v111
  v_lshl_add_u32 v36, v71, 3, v36
  v_and_b32 v71, -8, v36
  v_lshrrev_b32 v111, 1, v71
  ds_write_b32 v111, v70 offset:32768
  s_mov_b64 exec, s[44:45]
  s_cbranch_execz K2_WS8
  v_lshrrev_b32 v36, v112, v75
  v_bfe_u32 v75, v75, 0, v112
  v_lshl_add_u32 v36, v36, 8, v112
  v_lshl_add_u32 v36, v75, 3, v36
  v_and_b32 v75, -8, v36
  v_lshrrev_b32 v112, 1, v75
  ds_write_b32 v112, v74 offset:32768
K2_WS8:
  s_mov_b64 exec, s[46:47]
  s_cbranch_execz K2_WS9
  v_lshrrev_b32 v36, v113, v79
  v_bfe_u32 v79, v79, 0, v113
  v_lshl_add_u32 v36, v36, 8, v113
  v_lshl_add_u32 v36, v79, 3, v36
  v_and_b32 v79, -8, v36
  v_lshrrev_b32 v113, 1, v79
  ds_write_b32 v113, v78 offset:32768
K2_WS9:
  s_mov_b64 exec, s[48:49]
  s_cbranch_execz K2_WS10
  v_lshrrev_b32 v36, v114, v83
  v_bfe_u32 v83, v83, 0, v114
  v_lshl_add_u32 v36, v36, 8, v114
  v_lshl_add_u32 v36, v83, 3, v36
  v_and_b32 v83, -8, v36
  v_lshrrev_b32 v114, 1, v83
  ds_write_b32 v114, v82 offset:32768
K2_WS10:
  s_mov_b64 exec, s[50:51]
  s_cbranch_execz K2_WS11
  v_lshrrev_b32 v36, v115, v87
  v_bfe_u32 v87, v87, 0, v115
  v_lshl_add_u32 v36, v36, 8, v115
  v_lshl_add_u32 v36, v87, 3, v36
  v_and_b32 v87, -8, v36
  v_lshrrev_b32 v115, 1, v87
  ds_write_b32 v115, v86 offset:32768
K2_WS11:
  s_mov_b64 exec, s[52:53]
  s_cbranch_execz K2_WS12
  v_lshrrev_b32 v36, v116, v91
  v_bfe_u32 v91, v91, 0, v116
  v_lshl_add_u32 v36, v36, 8, v116
  v_lshl_add_u32 v36, v91, 3, v36
  v_and_b32 v91, -8, v36
  v_lshrrev_b32 v116, 1, v91
  ds_write_b32 v116, v90 offset:32768
K2_WS12:
  s_mov_b64 exec, s[54:55]
  s_cbranch_execz K2_WS13
  v_lshrrev_b32 v36, v117, v95
  v_bfe_u32 v95, v95, 0, v117
  v_lshl_add_u32 v36, v36, 8, v117
  v_lshl_add_u32 v36, v95, 3, v36
  v_and_b32 v95, -8, v36
  v_lshrrev_b32 v117, 1, v95
  ds_write_b32 v117, v94 offset:32768
K2_WS13:
  s_mov_b64 exec, s[56:57]
  s_cbranch_execz K2_WS14
  v_lshrrev_b32 v36, v118, v99
  v_bfe_u32 v99, v99, 0, v118
  v_lshl_add_u32 v36, v36, 8, v118
  v_lshl_add_u32 v36, v99, 3, v36
  v_and_b32 v99, -8, v36
  v_lshrrev_b32 v118, 1, v99
  ds_write_b32 v118, v98 offset:32768
K2_WS14:
  s_mov_b64 exec, s[58:59]
  s_cbranch_execz K2_WS15
  v_lshrrev_b32 v36, v119, v103
  v_bfe_u32 v103, v103, 0, v119
  v_lshl_add_u32 v36, v36, 8, v119
  v_lshl_add_u32 v36, v103, 3, v36
  v_and_b32 v103, -8, v36
  v_lshrrev_b32 v119, 1, v103
  ds_write_b32 v119, v102 offset:32768
K2_WS15:
  s_mov_b64 exec, -1
  s_sub_u32 s86, 11, s68
  s_cmp_lt_u32 s68, 4
  s_cselect_b32 s86, s68, s86
  s_add_u32 s78, s72, 0
  s_lshr_b32 s74, s78, 3
  s_and_b32 s78, s78, 7
  s_sub_u32 s83, 4, s78
  s_lshl_b32 s83, 15, s83
  s_and_b32 s83, s83, 15
  s_bfm_b32 s79, s78, 0
  s_cmp_le_u32 s78, 4
  s_cselect_b32 s83, s83, s79
  s_bfm_b32 s79, s86, 0
  s_and_b32 s79, s79, s83
  s_bcnt1_i32_b32 s79, s79
  s_mul_i32 s73, s74, s86
  s_add_u32 s73, s73, s79
  s_lshr_b32 s83, s83, s86
  s_and_b32 s83, s83, 1
  s_add_u32 s74, s74, s83
  s_add_u32 s74, s74, s73
  s_min_u32 s73, s73, s72
  s_min_u32 s74, s74, s72
  v_cmp_ge_u32 vcc, s73, v18
  s_and_b32 s86, vcc_lo, 0xffff
  s_bcnt1_i32_b32 s83, s86
  s_sub_u32 s83, s83, 1
  v_cmp_gt_u32 vcc, s74, v18
  s_and_b32 s86, vcc_lo, 0xffff
  s_bcnt1_i32_b32 s81, s86
  s_sub_u32 s81, s81, 1
  s_add_u32 s86, s83, 1
  v_readlane_b32 s87, v18, s83
  v_readlane_b32 s75, v18, s86
  s_sub_u32 s78, s74, s73
  s_mov_b32 s82, 0
  s_mov_b32 s89, 0
  s_mov_b32 s80, s83
  s_mov_b32 s88, s73
  s_mov_b32 s79, 1
  s_cmp_eq_u32 s78, 0
  s_cbranch_scc1 K2_FMD
  s_cmp_eq_u32 s87, s73
  s_cbranch_scc1 K2_FM
  s_mov_b32 s82, 1
  s_cmp_lt_u32 s75, s74
  s_cbranch_scc0 K2_ALLC
  s_add_u32 s80, s83, 1
  s_mov_b32 s88, s75
  s_sub_u32 s86, s74, s88
  s_bitset1_b32 s79, s86
  s_branch K2_FM
K2_ALLC:
  s_cmp_gt_u32 s75, s74
  s_cselect_b32 s89, 1, 0
K2_FM:
  s_mov_b32 s77, s80
K2_FML:
  s_cmp_ge_u32 s77, s81
  s_cbranch_scc1 K2_FMD
  s_add_u32 s77, s77, 1
  s_nop 3
  v_readlane_b32 s86, v18, s77
  s_sub_u32 s86, s86, s88
  s_bitset1_b32 s79, s86
  s_branch K2_FML
K2_FMD:
  s_add_u32 s86, s81, 1
  s_and_b32 s86, s86, 31
  s_nop 3
  v_readlane_b32 s87, v18, s86
  v_readlane_b32 s3, v18, 17
  s_sub_u32 s6, s74, s88
  s_cmp_gt_u32 s87, s74
  s_cselect_b32 s6, s6, 99
  s_cmp_lt_u32 s92, 168
  s_cselect_b32 s87, 30, 31
  s_cmp_eq_u32 s3, s87
  s_cselect_b32 s3, s71, 0
  s_cmp_gt_u32 s85, s70
  s_cselect_b32 s3, 0, s3
  s_lshl_b32 s93, s92, 7
  s_mov_b32 s7, 0xffff8000
  s_lshl_b32 s86, s88, 7
  v_add_u32 v16, s86, v15
  v_mad_u32_u24 v14, v12, s88, v13
  s_add_u32 s75, s88, 1
  s_cmp_eq_u32 s75, s74
  s_cselect_b32 s75, s73, s75
  s_waitcnt lgkmcnt(0)
  s_barrier
  ds_read_b128 v[4:7], v16
  s_lshl_b32 s86, s80, 5
  v_add_u32 v116, s86, v19
  ds_read_b128 v[24:27], v116
  s_lshl_b32 s86, s75, 7
  v_add_u32 v16, s86, v15
  s_mov_b32 m0, s84
  s_waitcnt lgkmcnt(1)
  v_lshl_add_u32 v4, v4, 7, v8
  v_lshl_add_u32 v5, v5, 7, v9
  v_lshl_add_u32 v6, v6, 7, v10
  v_lshl_add_u32 v7, v7, 7, v11
  buffer_load_dwordx4 v4, s[8:11], 0 offen lds
  s_add_u32 m0, s84, 1024
  s_nop 0
  buffer_load_dwordx4 v5, s[8:11], 0 offen lds
  s_add_u32 m0, s84, 2048
  s_nop 0
  buffer_load_dwordx4 v6, s[8:11], 0 offen lds
  s_add_u32 m0, s84, 3072
  s_nop 0
  buffer_load_dwordx4 v7, s[8:11], 0 offen lds
  ds_read_b128 v[4:7], v16
  s_mov_b64 exec, s[44:45]
  s_cbranch_execz K2_ES8
  ds_write_b64 v75, v[72:73] offset:0
K2_ES8:
  s_mov_b64 exec, s[46:47]
  s_cbranch_execz K2_ES9
  ds_write_b64 v79, v[76:77] offset:0
K2_ES9:
  s_mov_b64 exec, s[48:49]
  s_cbranch_execz K2_ES10
  ds_write_b64 v83, v[80:81] offset:0
K2_ES10:
  s_mov_b64 exec, s[50:51]
  s_cbranch_execz K2_ES11
  ds_write_b64 v87, v[84:85] offset:0
K2_ES11:
  s_mov_b64 exec, s[52:53]
  s_cbranch_execz K2_ES12
  ds_write_b64 v91, v[88:89] offset:0
K2_ES12:
  s_mov_b64 exec, s[54:55]
  s_cbranch_execz K2_ES13
  ds_write_b64 v95, v[92:93] offset:0
K2_ES13:
  s_mov_b64 exec, s[56:57]
  s_cbranch_execz K2_ES14
  ds_write_b64 v99, v[96:97] offset:0
K2_ES14:
  s_mov_b64 exec, s[58:59]
  s_cbranch_execz K2_ES15
  ds_write_b64 v103, v[100:101] offset:0
K2_ES15:
  s_mov_b64 exec, s[28:29]
  ds_write_b64 v43, v[40:41] offset:0
  s_mov_b64 exec, s[30:31]
  ds_write_b64 v47, v[44:45] offset:0
  s_mov_b64 exec, s[32:33]
  ds_write_b64 v51, v[48:49] offset:0
  s_mov_b64 exec, s[34:35]
  ds_write_b64 v55, v[52:53] offset:0
  s_mov_b64 exec, -1
  s_waitcnt lgkmcnt(0)
  v_add_u32 v24, v24, v17
  v_add_u32 v25, v25, v17
  v_add_u32 v26, v26, v17
  v_add_u32 v27, v27, v17
  ds_read_b32 v116, v24
  ds_read_b32 v117, v25
  ds_read_b32 v118, v26
  ds_read_b32 v119, v27
  s_waitcnt lgkmcnt(0)
  v_perm_b32 v30, v117, v116, s90
  v_perm_b32 v31, v119, v118, s90
  v_perm_b32 v34, v117, v116, s91
  v_perm_b32 v35, v119, v118, s91
  v_mov_b32 v20, v24
  v_mov_b32 v21, v25
  v_mov_b32 v22, v26
  v_mov_b32 v23, v27
  s_mov_b32 s4, s80
  s_add_u32 s86, s80, 1
  s_cmp_lt_u32 s80, s81
  s_cselect_b32 s80, s86, s83
  s_lshl_b32 s86, s80, 5
  v_add_u32 v116, s86, v19
  ds_read_b128 v[24:27], v116
  v_lshl_add_u32 v4, v4, 7, v8
  v_lshl_add_u32 v5, v5, 7, v9
  v_lshl_add_u32 v6, v6, 7, v10
  v_lshl_add_u32 v7, v7, 7, v11
  s_waitcnt vmcnt(0)
  ds_read_b128 a[70:73], v0
  ds_read_b128 a[74:77], v1
  ds_read_b128 a[78:81], v2
  ds_read_b128 a[82:85], v3
  s_mov_b64 exec, s[36:37]
  ds_write_b64 v59, v[56:57] offset:0
  s_mov_b64 exec, s[38:39]
  ds_write_b64 v63, v[60:61] offset:0
  s_mov_b64 exec, s[40:41]
  ds_write_b64 v67, v[64:65] offset:0
  s_mov_b64 exec, s[42:43]
  ds_write_b64 v71, v[68:69] offset:0
  s_mov_b64 exec, -1
  s_add_u32 s76, s75, 1
  s_cmp_eq_u32 s76, s74
  s_cselect_b32 s76, s73, s76
  s_lshl_b32 s86, s76, 7
  v_add_u32 v16, s86, v15
  s_mov_b32 m0, s84
  s_waitcnt lgkmcnt(4)
  buffer_load_dwordx4 v4, s[8:11], 0 offen lds
  s_add_u32 m0, s84, 1024
  s_nop 0
  buffer_load_dwordx4 v5, s[8:11], 0 offen lds
  s_add_u32 m0, s84, 2048
  s_nop 0
  buffer_load_dwordx4 v6, s[8:11], 0 offen lds
  s_add_u32 m0, s84, 3072
  s_nop 0
  buffer_load_dwordx4 v7, s[8:11], 0 offen lds
  v_lshrrev_b32 v112, 8, v20
  v_mul_u32_u24 v112, 10923, v112
  v_subrev_u32 v112, 3626436, v112
  v_and_or_b32 v112, v112, s7, v17
  v_lshrrev_b32 v113, 8, v21
  v_mul_u32_u24 v113, 10923, v113
  v_subrev_u32 v113, 3626436, v113
  v_and_or_b32 v113, v113, s7, v17
  v_lshrrev_b32 v114, 8, v22
  v_mul_u32_u24 v114, 10923, v114
  v_subrev_u32 v114, 3626436, v114
  v_and_or_b32 v114, v114, s7, v17
  v_lshrrev_b32 v115, 8, v23
  v_mul_u32_u24 v115, 10923, v115
  v_subrev_u32 v115, 3626436, v115
  v_and_or_b32 v115, v115, s7, v17
  buffer_load_dword v36, v112, s[8:11], s93 offen
  buffer_load_dword v37, v113, s[8:11], s93 offen
  buffer_load_dword v38, v114, s[8:11], s93 offen
  buffer_load_dword v39, v115, s[8:11], s93 offen
  ds_read_b128 v[4:7], v16
  s_waitcnt lgkmcnt(0)
  s_barrier
  s_cmp_eq_u32 s78, 0
  s_cbranch_scc1 K2_LOOPDONE
  ds_read2_b32 a[64:65], v14 offset0:0 offset1:1
  v_mad_u32_u24 v14, v12, s75, v13
  s_mov_b32 s75, s76
  v_mfma_f32_32x32x16_bf16 v[40:55], a[70:73], a[0:3], 0
  v_mfma_f32_32x32x16_bf16 v[40:55], a[74:77], a[8:11], v[40:55]
  v_mfma_f32_32x32x16_bf16 v[40:55], a[78:81], a[16:19], v[40:55]
  v_mfma_f32_32x32x16_bf16 v[40:55], a[82:85], a[24:27], v[40:55]
  s_waitcnt lgkmcnt(0)
  v_mfma_f32_32x32x16_bf16 v[40:55], a[64:67], v[28:31], v[40:55]
  v_mfma_f32_32x32x16_bf16 v[56:71], a[64:67], v[32:35], 0
  v_mfma_f32_32x32x16_bf16 v[56:71], a[70:73], a[4:7], v[56:71]
  ds_read2_b32 a[64:65], v14 offset0:0 offset1:1
  v_mfma_f32_32x32x16_bf16 v[56:71], a[74:77], a[12:15], v[56:71]
  v_mfma_f32_32x32x16_bf16 v[56:71], a[78:81], a[20:23], v[56:71]
  v_mfma_f32_32x32x16_bf16 v[56:71], a[82:85], a[28:31], v[56:71]
  s_bitcmp1_b32 s79, 1
  s_cbranch_scc0 K2_FNM
  s_waitcnt lgkmcnt(0)
  v_add_u32 v24, v24, v17
  v_add_u32 v25, v25, v17
  v_add_u32 v26, v26, v17
  v_add_u32 v27, v27, v17
  ds_read_b32 v116, v24
  ds_read_b32 v117, v25
  ds_read_b32 v118, v26
  ds_read_b32 v119, v27
  s_waitcnt lgkmcnt(0)
  v_perm_b32 v30, v117, v116, s90
  v_perm_b32 v31, v119, v118, s90
  v_perm_b32 v34, v117, v116, s91
  v_perm_b32 v35, v119, v118, s91
K2_FNM:
  s_nop 5
  v_exp_f32 v40, v40
  v_exp_f32 v41, v41
  v_exp_f32 v42, v42
  v_exp_f32 v43, v43
  v_exp_f32 v44, v44
  v_exp_f32 v45, v45
  v_exp_f32 v46, v46
  v_exp_f32 v47, v47
  v_exp_f32 v48, v48
  v_exp_f32 v49, v49
  v_exp_f32 v50, v50
  v_exp_f32 v51, v51
  v_exp_f32 v52, v52
  v_exp_f32 v53, v53
  v_exp_f32 v54, v54
  v_exp_f32 v55, v55
  s_mov_b32 s77, 0
  s_waitcnt vmcnt(0)
  v_mfma_f32_32x32x8_bf16 v[40:55], a[68:69], a[68:69], v[40:55]
  ds_read_b128 a[86:89], v0
  ds_read_b128 a[90:93], v1
  ds_read_b128 a[94:97], v2
  ds_read_b128 a[98:101], v3
K2_LOOP:
  s_setprio 0
  s_waitcnt lgkmcnt(0)
  v_lshl_add_u32 v4, v4, 7, v8
  v_lshl_add_u32 v5, v5, 7, v9
  v_mfma_f32_32x32x16_bf16 v[104:119], a[70:73], a[32:35], 0
  s_mov_b32 m0, s84
  v_lshl_add_u32 v6, v6, 7, v10
  v_lshl_add_u32 v7, v7, 7, v11
  v_exp_f32 v56, v56
  v_exp_f32 v57, v57
  v_exp_f32 v58, v58
  v_mfma_f32_32x32x16_bf16 v[72:87], a[64:67], v[28:31], 0
  buffer_load_dwordx4 v4, s[8:11], 0 offen lds
  s_add_u32 m0, s84, 1024
  v_exp_f32 v59, v59
  v_exp_f32 v60, v60
  v_exp_f32 v61, v61
  v_mfma_f32_32x32x16_bf16 v[104:119], a[74:77], a[40:43], v[104:119]
  buffer_load_dwordx4 v5, s[8:11], 0 offen lds
  s_add_u32 m0, s84, 2048
  v_exp_f32 v62, v62
  v_exp_f32 v63, v63
  v_exp_f32 v64, v64
  v_mfma_f32_32x32x16_bf16 v[72:87], a[86:89], a[0:3], v[72:87]
  buffer_load_dwordx4 v6, s[8:11], 0 offen lds
  s_add_u32 m0, s84, 3072
  v_exp_f32 v65, v65
  v_exp_f32 v66, v66
  v_exp_f32 v67, v67
  v_mfma_f32_32x32x16_bf16 v[104:119], a[78:81], a[48:51], v[104:119]
  buffer_load_dwordx4 v7, s[8:11], 0 offen lds
  s_add_u32 s76, s75, 1
  v_exp_f32 v68, v68
  v_exp_f32 v69, v69
  v_exp_f32 v70, v70
  v_mfma_f32_32x32x16_bf16 v[72:87], a[90:93], a[8:11], v[72:87]
  s_cmp_eq_u32 s76, s74
  s_cselect_b32 s76, s73, s76
  v_exp_f32 v71, v71
  v_rcp_f32 v40, v40
  v_rcp_f32 v41, v41
  v_mfma_f32_32x32x8_bf16 v[56:71], a[68:69], a[68:69], v[56:71]
  v_rcp_f32 v42, v42
  v_rcp_f32 v43, v43
  v_rcp_f32 v44, v44
  v_mfma_f32_32x32x16_bf16 v[104:119], a[82:85], a[56:59], v[104:119]
  s_lshl_b32 s86, s76, 7
  v_add_u32 v16, s86, v15
  v_rcp_f32 v45, v45
  v_rcp_f32 v46, v46
  v_rcp_f32 v47, v47
  v_mfma_f32_32x32x16_bf16 v[72:87], a[94:97], a[16:19], v[72:87]
  ds_read_b128 v[4:7], v16
  v_mad_u32_u24 v14, v12, s75, v13
  v_rcp_f32 v48, v48
  v_rcp_f32 v49, v49
  v_rcp_f32 v50, v50
  v_mfma_f32_32x32x16_bf16 v[72:87], a[98:101], a[24:27], v[72:87]
  s_mov_b32 s75, s76
  v_rcp_f32 v51, v51
  v_rcp_f32 v52, v52
  v_rcp_f32 v53, v53
  v_rcp_f32 v54, v54
  v_rcp_f32 v55, v55
  s_setprio 1
  s_bitcmp1_b32 s79, s77
  s_cbranch_scc0 K2_PN0
  v_pk_mul_f32 v[120:121], v[40:41], v[104:105]
  v_pk_add_f32 v[122:123], v[40:41], v[42:43]
  v_pk_mul_f32 v[124:125], v[44:45], v[108:109]
  v_pk_add_f32 v[126:127], v[44:45], v[46:47]
  v_pk_mul_f32 v[128:129], v[48:49], v[112:113]
  v_pk_add_f32 v[130:131], v[48:49], v[50:51]
  v_pk_mul_f32 v[132:133], v[52:53], v[116:117]
  v_pk_add_f32 v[134:135], v[52:53], v[54:55]
  v_pk_fma_f32 v[120:121], v[42:43], v[106:107], v[120:121]
  v_pk_fma_f32 v[124:125], v[46:47], v[110:111], v[124:125]
  v_pk_fma_f32 v[128:129], v[50:51], v[114:115], v[128:129]
  v_pk_fma_f32 v[132:133], v[54:55], v[118:119], v[132:133]
  s_branch K2_PE0
K2_PN0:
  v_pk_fma_f32 v[120:121], v[40:41], v[104:105], v[120:121]
  v_pk_add_f32 v[122:123], v[40:41], v[122:123]
  v_pk_fma_f32 v[124:125], v[44:45], v[108:109], v[124:125]
  v_pk_add_f32 v[126:127], v[44:45], v[126:127]
  v_pk_fma_f32 v[128:129], v[48:49], v[112:113], v[128:129]
  v_pk_add_f32 v[130:131], v[48:49], v[130:131]
  v_pk_fma_f32 v[132:133], v[52:53], v[116:117], v[132:133]
  v_pk_add_f32 v[134:135], v[52:53], v[134:135]
  v_pk_fma_f32 v[120:121], v[42:43], v[106:107], v[120:121]
  v_pk_add_f32 v[122:123], v[42:43], v[122:123]
  v_pk_fma_f32 v[124:125], v[46:47], v[110:111], v[124:125]
  v_pk_add_f32 v[126:127], v[46:47], v[126:127]
  v_pk_fma_f32 v[128:129], v[50:51], v[114:115], v[128:129]
  v_pk_add_f32 v[130:131], v[50:51], v[130:131]
  v_pk_fma_f32 v[132:133], v[54:55], v[118:119], v[132:133]
  v_pk_add_f32 v[134:135], v[54:55], v[134:135]
K2_PE0:
  s_setprio 0
  v_mfma_f32_32x32x16_bf16 v[104:119], a[70:73], a[36:39], 0
  v_exp_f32 v72, v72
  v_exp_f32 v73, v73
  v_exp_f32 v74, v74
  v_mfma_f32_32x32x16_bf16 v[88:103], a[64:67], v[32:35], 0
  v_exp_f32 v75, v75
  v_exp_f32 v76, v76
  v_exp_f32 v77, v77
  v_mfma_f32_32x32x16_bf16 v[104:119], a[74:77], a[44:47], v[104:119]
  ds_read2_b32 a[64:65], v14 offset0:0 offset1:1
  v_exp_f32 v78, v78
  v_exp_f32 v79, v79
  v_exp_f32 v80, v80
  v_mfma_f32_32x32x16_bf16 v[88:103], a[86:89], a[4:7], v[88:103]
  v_exp_f32 v81, v81
  v_exp_f32 v82, v82
  v_exp_f32 v83, v83
  v_mfma_f32_32x32x16_bf16 v[104:119], a[78:81], a[52:55], v[104:119]
  v_exp_f32 v84, v84
  v_exp_f32 v85, v85
  v_exp_f32 v86, v86
  v_mfma_f32_32x32x16_bf16 v[88:103], a[90:93], a[12:15], v[88:103]
  v_exp_f32 v87, v87
  v_rcp_f32 v56, v56
  v_rcp_f32 v57, v57
  v_mfma_f32_32x32x8_bf16 v[72:87], a[68:69], a[68:69], v[72:87]
  v_rcp_f32 v58, v58
  v_rcp_f32 v59, v59
  v_rcp_f32 v60, v60
  v_mfma_f32_32x32x16_bf16 v[104:119], a[82:85], a[60:63], v[104:119]
  s_waitcnt vmcnt(0)
  v_rcp_f32 v61, v61
  v_rcp_f32 v62, v62
  v_rcp_f32 v63, v63
  v_mfma_f32_32x32x16_bf16 v[88:103], a[94:97], a[20:23], v[88:103]
  ds_read_b128 a[70:73], v0
  ds_read_b128 a[74:77], v1
  v_rcp_f32 v64, v64
  v_rcp_f32 v65, v65
  v_rcp_f32 v66, v66
  v_mfma_f32_32x32x16_bf16 v[88:103], a[98:101], a[28:31], v[88:103]
  ds_read_b128 a[78:81], v2
  ds_read_b128 a[82:85], v3
  v_rcp_f32 v67, v67
  v_rcp_f32 v68, v68
  v_rcp_f32 v69, v69
  v_rcp_f32 v70, v70
  v_rcp_f32 v71, v71
  s_setprio 1
  s_bitcmp1_b32 s79, s77
  s_cbranch_scc0 K2_PN1
  v_pk_mul_f32 v[136:137], v[56:57], v[104:105]
  v_pk_add_f32 v[138:139], v[56:57], v[58:59]
  v_pk_mul_f32 v[140:141], v[60:61], v[108:109]
  v_pk_add_f32 v[142:143], v[60:61], v[62:63]
  v_pk_mul_f32 v[144:145], v[64:65], v[112:113]
  v_pk_add_f32 v[146:147], v[64:65], v[66:67]
  v_pk_mul_f32 v[148:149], v[68:69], v[116:117]
  v_pk_add_f32 v[150:151], v[68:69], v[70:71]
  v_pk_fma_f32 v[136:137], v[58:59], v[106:107], v[136:137]
  v_pk_fma_f32 v[140:141], v[62:63], v[110:111], v[140:141]
  v_pk_fma_f32 v[144:145], v[66:67], v[114:115], v[144:145]
  v_pk_fma_f32 v[148:149], v[70:71], v[118:119], v[148:149]
  s_branch K2_PE1
K2_PN1:
  v_pk_fma_f32 v[136:137], v[56:57], v[104:105], v[136:137]
  v_pk_add_f32 v[138:139], v[56:57], v[138:139]
  v_pk_fma_f32 v[140:141], v[60:61], v[108:109], v[140:141]
  v_pk_add_f32 v[142:143], v[60:61], v[142:143]
  v_pk_fma_f32 v[144:145], v[64:65], v[112:113], v[144:145]
  v_pk_add_f32 v[146:147], v[64:65], v[146:147]
  v_pk_fma_f32 v[148:149], v[68:69], v[116:117], v[148:149]
  v_pk_add_f32 v[150:151], v[68:69], v[150:151]
  v_pk_fma_f32 v[136:137], v[58:59], v[106:107], v[136:137]
  v_pk_add_f32 v[138:139], v[58:59], v[138:139]
  v_pk_fma_f32 v[140:141], v[62:63], v[110:111], v[140:141]
  v_pk_add_f32 v[142:143], v[62:63], v[142:143]
  v_pk_fma_f32 v[144:145], v[66:67], v[114:115], v[144:145]
  v_pk_add_f32 v[146:147], v[66:67], v[146:147]
  v_pk_fma_f32 v[148:149], v[70:71], v[118:119], v[148:149]
  v_pk_add_f32 v[150:151], v[70:71], v[150:151]
K2_PE1:
  s_add_u32 s77, s77, 1
  s_cmp_ge_u32 s77, s78
  s_cbranch_scc1 K2_LAST
  s_bitcmp1_b32 s79, s77
  s_cbranch_scc1 K2_EV
K2_NF0:
  s_add_u32 s86, s77, 1
  s_bitcmp1_b32 s79, s86
  s_cbranch_scc0 K2_NM0
  s_waitcnt lgkmcnt(0)
  v_add_u32 v24, v24, v17
  v_add_u32 v25, v25, v17
  v_add_u32 v26, v26, v17
  v_add_u32 v27, v27, v17
  ds_read_b32 v116, v24
  ds_read_b32 v117, v25
  ds_read_b32 v118, v26
  ds_read_b32 v119, v27
  s_waitcnt lgkmcnt(0)
  v_perm_b32 v30, v117, v116, s90
  v_perm_b32 v31, v119, v118, s90
  v_perm_b32 v34, v117, v116, s91
  v_perm_b32 v35, v119, v118, s91
K2_NM0:
  s_setprio 0
  s_waitcnt lgkmcnt(0)
  v_lshl_add_u32 v4, v4, 7, v8
  v_lshl_add_u32 v5, v5, 7, v9
  v_mfma_f32_32x32x16_bf16 v[104:119], a[86:89], a[32:35], 0
  s_mov_b32 m0, s84
  v_lshl_add_u32 v6, v6, 7, v10
  v_lshl_add_u32 v7, v7, 7, v11
  v_exp_f32 v88, v88
  v_exp_f32 v89, v89
  v_exp_f32 v90, v90
  v_mfma_f32_32x32x16_bf16 v[40:55], a[64:67], v[28:31], 0
  buffer_load_dwordx4 v4, s[8:11], 0 offen lds
  s_add_u32 m0, s84, 1024
  v_exp_f32 v91, v91
  v_exp_f32 v92, v92
  v_exp_f32 v93, v93
  v_mfma_f32_32x32x16_bf16 v[104:119], a[90:93], a[40:43], v[104:119]
  buffer_load_dwordx4 v5, s[8:11], 0 offen lds
  s_add_u32 m0, s84, 2048
  v_exp_f32 v94, v94
  v_exp_f32 v95, v95
  v_exp_f32 v96, v96
  v_mfma_f32_32x32x16_bf16 v[40:55], a[70:73], a[0:3], v[40:55]
  buffer_load_dwordx4 v6, s[8:11], 0 offen lds
  s_add_u32 m0, s84, 3072
  v_exp_f32 v97, v97
  v_exp_f32 v98, v98
  v_exp_f32 v99, v99
  v_mfma_f32_32x32x16_bf16 v[104:119], a[94:97], a[48:51], v[104:119]
  buffer_load_dwordx4 v7, s[8:11], 0 offen lds
  s_add_u32 s76, s75, 1
  v_exp_f32 v100, v100
  v_exp_f32 v101, v101
  v_exp_f32 v102, v102
  v_mfma_f32_32x32x16_bf16 v[40:55], a[74:77], a[8:11], v[40:55]
  s_cmp_eq_u32 s76, s74
  s_cselect_b32 s76, s73, s76
  v_exp_f32 v103, v103
  v_rcp_f32 v72, v72
  v_rcp_f32 v73, v73
  v_mfma_f32_32x32x8_bf16 v[88:103], a[68:69], a[68:69], v[88:103]
  v_rcp_f32 v74, v74
  v_rcp_f32 v75, v75
  v_rcp_f32 v76, v76
  v_mfma_f32_32x32x16_bf16 v[104:119], a[98:101], a[56:59], v[104:119]
  s_lshl_b32 s86, s76, 7
  v_add_u32 v16, s86, v15
  v_rcp_f32 v77, v77
  v_rcp_f32 v78, v78
  v_rcp_f32 v79, v79
  v_mfma_f32_32x32x16_bf16 v[40:55], a[78:81], a[16:19], v[40:55]
  ds_read_b128 v[4:7], v16
  v_mad_u32_u24 v14, v12, s75, v13
  v_rcp_f32 v80, v80
  v_rcp_f32 v81, v81
  v_rcp_f32 v82, v82
  v_mfma_f32_32x32x16_bf16 v[40:55], a[82:85], a[24:27], v[40:55]
  s_mov_b32 s75, s76
  v_rcp_f32 v83, v83
  v_rcp_f32 v84, v84
  v_rcp_f32 v85, v85
  v_rcp_f32 v86, v86
  v_rcp_f32 v87, v87
  s_setprio 1
  s_bitcmp1_b32 s79, s77
  s_cbranch_scc0 K2_PN2
  v_pk_mul_f32 v[120:121], v[72:73], v[104:105]
  v_pk_add_f32 v[122:123], v[72:73], v[74:75]
  v_pk_mul_f32 v[124:125], v[76:77], v[108:109]
  v_pk_add_f32 v[126:127], v[76:77], v[78:79]
  v_pk_mul_f32 v[128:129], v[80:81], v[112:113]
  v_pk_add_f32 v[130:131], v[80:81], v[82:83]
  v_pk_mul_f32 v[132:133], v[84:85], v[116:117]
  v_pk_add_f32 v[134:135], v[84:85], v[86:87]
  v_pk_fma_f32 v[120:121], v[74:75], v[106:107], v[120:121]
  v_pk_fma_f32 v[124:125], v[78:79], v[110:111], v[124:125]
  v_pk_fma_f32 v[128:129], v[82:83], v[114:115], v[128:129]
  v_pk_fma_f32 v[132:133], v[86:87], v[118:119], v[132:133]
  s_branch K2_PE2
K2_PN2:
  v_pk_fma_f32 v[120:121], v[72:73], v[104:105], v[120:121]
  v_pk_add_f32 v[122:123], v[72:73], v[122:123]
  v_pk_fma_f32 v[124:125], v[76:77], v[108:109], v[124:125]
  v_pk_add_f32 v[126:127], v[76:77], v[126:127]
  v_pk_fma_f32 v[128:129], v[80:81], v[112:113], v[128:129]
  v_pk_add_f32 v[130:131], v[80:81], v[130:131]
  v_pk_fma_f32 v[132:133], v[84:85], v[116:117], v[132:133]
  v_pk_add_f32 v[134:135], v[84:85], v[134:135]
  v_pk_fma_f32 v[120:121], v[74:75], v[106:107], v[120:121]
  v_pk_add_f32 v[122:123], v[74:75], v[122:123]
  v_pk_fma_f32 v[124:125], v[78:79], v[110:111], v[124:125]
  v_pk_add_f32 v[126:127], v[78:79], v[126:127]
  v_pk_fma_f32 v[128:129], v[82:83], v[114:115], v[128:129]
  v_pk_add_f32 v[130:131], v[82:83], v[130:131]
  v_pk_fma_f32 v[132:133], v[86:87], v[118:119], v[132:133]
  v_pk_add_f32 v[134:135], v[86:87], v[134:135]
K2_PE2:
  s_setprio 0
  v_mfma_f32_32x32x16_bf16 v[104:119], a[86:89], a[36:39], 0
  v_exp_f32 v40, v40
  v_exp_f32 v41, v41
  v_exp_f32 v42, v42
  v_mfma_f32_32x32x16_bf16 v[56:71], a[64:67], v[32:35], 0
  v_exp_f32 v43, v43
  v_exp_f32 v44, v44
  v_exp_f32 v45, v45
  v_mfma_f32_32x32x16_bf16 v[104:119], a[90:93], a[44:47], v[104:119]
  ds_read2_b32 a[64:65], v14 offset0:0 offset1:1
  v_exp_f32 v46, v46
  v_exp_f32 v47, v47
  v_exp_f32 v48, v48
  v_mfma_f32_32x32x16_bf16 v[56:71], a[70:73], a[4:7], v[56:71]
  v_exp_f32 v49, v49
  v_exp_f32 v50, v50
  v_exp_f32 v51, v51
  v_mfma_f32_32x32x16_bf16 v[104:119], a[94:97], a[52:55], v[104:119]
  v_exp_f32 v52, v52
  v_exp_f32 v53, v53
  v_exp_f32 v54, v54
  v_mfma_f32_32x32x16_bf16 v[56:71], a[74:77], a[12:15], v[56:71]
  v_exp_f32 v55, v55
  v_rcp_f32 v88, v88
  v_rcp_f32 v89, v89
  v_mfma_f32_32x32x8_bf16 v[40:55], a[68:69], a[68:69], v[40:55]
  v_rcp_f32 v90, v90
  v_rcp_f32 v91, v91
  v_rcp_f32 v92, v92
  v_mfma_f32_32x32x16_bf16 v[104:119], a[98:101], a[60:63], v[104:119]
  s_waitcnt vmcnt(0)
  v_rcp_f32 v93, v93
  v_rcp_f32 v94, v94
  v_rcp_f32 v95, v95
  v_mfma_f32_32x32x16_bf16 v[56:71], a[78:81], a[20:23], v[56:71]
  ds_read_b128 a[86:89], v0
  ds_read_b128 a[90:93], v1
  v_rcp_f32 v96, v96
  v_rcp_f32 v97, v97
  v_rcp_f32 v98, v98
  v_mfma_f32_32x32x16_bf16 v[56:71], a[82:85], a[28:31], v[56:71]
  ds_read_b128 a[94:97], v2
  ds_read_b128 a[98:101], v3
  v_rcp_f32 v99, v99
  v_rcp_f32 v100, v100
  v_rcp_f32 v101, v101
  v_rcp_f32 v102, v102
  v_rcp_f32 v103, v103
  s_setprio 1
  s_bitcmp1_b32 s79, s77
  s_cbranch_scc0 K2_PN3
  v_pk_mul_f32 v[136:137], v[88:89], v[104:105]
  v_pk_add_f32 v[138:139], v[88:89], v[90:91]
  v_pk_mul_f32 v[140:141], v[92:93], v[108:109]
  v_pk_add_f32 v[142:143], v[92:93], v[94:95]
  v_pk_mul_f32 v[144:145], v[96:97], v[112:113]
  v_pk_add_f32 v[146:147], v[96:97], v[98:99]
  v_pk_mul_f32 v[148:149], v[100:101], v[116:117]
  v_pk_add_f32 v[150:151], v[100:101], v[102:103]
  v_pk_fma_f32 v[136:137], v[90:91], v[106:107], v[136:137]
  v_pk_fma_f32 v[140:141], v[94:95], v[110:111], v[140:141]
  v_pk_fma_f32 v[144:145], v[98:99], v[114:115], v[144:145]
  v_pk_fma_f32 v[148:149], v[102:103], v[118:119], v[148:149]
  s_branch K2_PE3
K2_PN3:
  v_pk_fma_f32 v[136:137], v[88:89], v[104:105], v[136:137]
  v_pk_add_f32 v[138:139], v[88:89], v[138:139]
  v_pk_fma_f32 v[140:141], v[92:93], v[108:109], v[140:141]
  v_pk_add_f32 v[142:143], v[92:93], v[142:143]
  v_pk_fma_f32 v[144:145], v[96:97], v[112:113], v[144:145]
  v_pk_add_f32 v[146:147], v[96:97], v[146:147]
  v_pk_fma_f32 v[148:149], v[100:101], v[116:117], v[148:149]
  v_pk_add_f32 v[150:151], v[100:101], v[150:151]
  v_pk_fma_f32 v[136:137], v[90:91], v[106:107], v[136:137]
  v_pk_add_f32 v[138:139], v[90:91], v[138:139]
  v_pk_fma_f32 v[140:141], v[94:95], v[110:111], v[140:141]
  v_pk_add_f32 v[142:143], v[94:95], v[142:143]
  v_pk_fma_f32 v[144:145], v[98:99], v[114:115], v[144:145]
  v_pk_add_f32 v[146:147], v[98:99], v[146:147]
  v_pk_fma_f32 v[148:149], v[102:103], v[118:119], v[148:149]
  v_pk_add_f32 v[150:151], v[102:103], v[150:151]
K2_PE3:
  s_add_u32 s77, s77, 1
  s_cmp_ge_u32 s77, s78
  s_cbranch_scc1 K2_LAST
  s_bitcmp1_b32 s79, s77
  s_cbranch_scc1 K2_EV
K2_NF1:
  s_add_u32 s86, s77, 1
  s_bitcmp1_b32 s79, s86
  s_cbranch_scc0 K2_NM1
  s_waitcnt lgkmcnt(0)
  v_add_u32 v24, v24, v17
  v_add_u32 v25, v25, v17
  v_add_u32 v26, v26, v17
  v_add_u32 v27, v27, v17
  ds_read_b32 v116, v24
  ds_read_b32 v117, v25
  ds_read_b32 v118, v26
  ds_read_b32 v119, v27
  s_waitcnt lgkmcnt(0)
  v_perm_b32 v30, v117, v116, s90
  v_perm_b32 v31, v119, v118, s90
  v_perm_b32 v34, v117, v116, s91
  v_perm_b32 v35, v119, v118, s91
K2_NM1:
  s_branch K2_LOOP
K2_LAST:
  s_setprio 0
  s_cmp_eq_u32 s82, 0
  s_cbranch_scc1 K2_EV
  s_cmp_lg_u32 s4, 0
  s_cbranch_scc1 K2_WRC
  v_pk_add_f32 v[120:121], v[120:121], v[124:125]
  v_pk_add_f32 v[122:123], v[122:123], v[126:127]
  v_pk_add_f32 v[128:129], v[128:129], v[132:133]
  v_pk_add_f32 v[130:131], v[130:131], v[134:135]
  v_pk_add_f32 v[136:137], v[136:137], v[140:141]
  v_pk_add_f32 v[138:139], v[138:139], v[142:143]
  v_pk_add_f32 v[144:145], v[144:145], v[148:149]
  v_pk_add_f32 v[146:147], v[146:147], v[150:151]
  v_add_f32 v120, v120, v121
  v_add_f32 v122, v122, v123
  v_add_f32 v128, v128, v129
  v_add_f32 v130, v130, v131
  v_add_f32 v136, v136, v137
  v_add_f32 v138, v138, v139
  v_add_f32 v144, v144, v145
  v_add_f32 v146, v146, v147
  v_mov_b32 v121, v120
  v_mov_b32 v123, v122
  v_mov_b32 v129, v128
  v_mov_b32 v131, v130
  v_mov_b32 v137, v136
  v_mov_b32 v139, v138
  v_mov_b32 v145, v144
  v_mov_b32 v147, v146
  s_nop 1
  v_permlane32_swap_b32 v120, v121
  v_permlane32_swap_b32 v122, v123
  v_permlane32_swap_b32 v128, v129
  v_permlane32_swap_b32 v130, v131
  v_permlane32_swap_b32 v136, v137
  v_permlane32_swap_b32 v138, v139
  v_permlane32_swap_b32 v144, v145
  v_permlane32_swap_b32 v146, v147
  s_nop 1
  v_mov_b32 v124, v120
  v_mov_b32 v125, v121
  v_mov_b32 v126, v122
  v_mov_b32 v127, v123
  v_mov_b32 v132, v128
  v_mov_b32 v133, v129
  v_mov_b32 v134, v130
  v_mov_b32 v135, v131
  v_mov_b32 v140, v136
  v_mov_b32 v141, v137
  v_mov_b32 v142, v138
  v_mov_b32 v143, v139
  v_mov_b32 v148, v144
  v_mov_b32 v149, v145
  v_mov_b32 v150, v146
  v_mov_b32 v151, v147
K2_WRC:
  s_branch K2_LOOPDONE
K2_EV:
  s_cmp_lg_u32 s4, 0
  s_cbranch_scc1 K2_WRE
  v_pk_add_f32 v[120:121], v[120:121], v[124:125]
  v_pk_add_f32 v[122:123], v[122:123], v[126:127]
  v_pk_add_f32 v[128:129], v[128:129], v[132:133]
  v_pk_add_f32 v[130:131], v[130:131], v[134:135]
  v_pk_add_f32 v[136:137], v[136:137], v[140:141]
  v_pk_add_f32 v[138:139], v[138:139], v[142:143]
  v_pk_add_f32 v[144:145], v[144:145], v[148:149]
  v_pk_add_f32 v[146:147], v[146:147], v[150:151]
  v_add_f32 v120, v120, v121
  v_add_f32 v122, v122, v123
  v_add_f32 v128, v128, v129
  v_add_f32 v130, v130, v131
  v_add_f32 v136, v136, v137
  v_add_f32 v138, v138, v139
  v_add_f32 v144, v144, v145
  v_add_f32 v146, v146, v147
  v_mov_b32 v121, v120
  v_mov_b32 v123, v122
  v_mov_b32 v129, v128
  v_mov_b32 v131, v130
  v_mov_b32 v137, v136
  v_mov_b32 v139, v138
  v_mov_b32 v145, v144
  v_mov_b32 v147, v146
  s_nop 1
  v_permlane32_swap_b32 v120, v121
  v_permlane32_swap_b32 v122, v123
  v_permlane32_swap_b32 v128, v129
  v_permlane32_swap_b32 v130, v131
  v_permlane32_swap_b32 v136, v137
  v_permlane32_swap_b32 v138, v139
  v_permlane32_swap_b32 v144, v145
  v_permlane32_swap_b32 v146, v147
  s_nop 1
  v_mov_b32 v124, v120
  v_mov_b32 v125, v121
  v_mov_b32 v126, v122
  v_mov_b32 v127, v123
  v_mov_b32 v132, v128
  v_mov_b32 v133, v129
  v_mov_b32 v134, v130
  v_mov_b32 v135, v131
  v_mov_b32 v140, v136
  v_mov_b32 v141, v137
  v_mov_b32 v142, v138
  v_mov_b32 v143, v139
  v_mov_b32 v148, v144
  v_mov_b32 v149, v145
  v_mov_b32 v150, v146
  v_mov_b32 v151, v147
K2_WRE:
  s_cmp_eq_u32 s77, s6
  s_cbranch_scc1 K2_EVS
  s_cmp_eq_u32 s3, 0
  s_cbranch_scc1 K2_EVS
  ds_read_b32 v108, v20 offset:128
  ds_read_b32 v109, v21 offset:128
  ds_read_b32 v110, v22 offset:128
  ds_read_b32 v111, v23 offset:128
  v_lshrrev_b32 v112, 8, v20
  v_mul_u32_u24 v112, 10923, v112
  v_subrev_u32 v112, 3626436, v112
  v_and_or_b32 v112, v112, s7, v17
  v_lshrrev_b32 v113, 8, v21
  v_mul_u32_u24 v113, 10923, v113
  v_subrev_u32 v113, 3626436, v113
  v_and_or_b32 v113, v113, s7, v17
  v_lshrrev_b32 v114, 8, v22
  v_mul_u32_u24 v114, 10923, v114
  v_subrev_u32 v114, 3626436, v114
  v_and_or_b32 v114, v114, s7, v17
  v_lshrrev_b32 v115, 8, v23
  v_mul_u32_u24 v115, 10923, v115
  v_subrev_u32 v115, 3626436, v115
  v_and_or_b32 v115, v115, s7, v17
  v_add_f32 v120, v120, v121
  v_add_f32 v122, v122, v123
  v_add_f32 v124, v124, v125
  v_add_f32 v126, v126, v127
  v_add_f32 v128, v128, v129
  v_add_f32 v130, v130, v131
  v_add_f32 v132, v132, v133
  v_add_f32 v134, v134, v135
  v_add_f32 v136, v136, v137
  v_add_f32 v138, v138, v139
  v_add_f32 v140, v140, v141
  v_add_f32 v142, v142, v143
  v_add_f32 v144, v144, v145
  v_add_f32 v146, v146, v147
  v_add_f32 v148, v148, v149
  v_add_f32 v150, v150, v151
  ds_write2_b32 v20, v120, v122 offset0:64 offset1:128
  ds_write2_b32 v21, v124, v126 offset0:64 offset1:128
  ds_write2_b32 v22, v128, v130 offset0:64 offset1:128
  ds_write2_b32 v23, v132, v134 offset0:64 offset1:128
  ds_write2_b32 v20, v136, v138 offset0:96 offset1:160
  ds_write2_b32 v21, v140, v142 offset0:96 offset1:160
  ds_write2_b32 v22, v144, v146 offset0:96 offset1:160
  ds_write2_b32 v23, v148, v150 offset0:96 offset1:160
  s_mov_b32 s86, 0x358637bd
  v_add_f32 v122, s86, v122
  v_add_f32 v126, s86, v126
  v_add_f32 v130, s86, v130
  v_add_f32 v134, s86, v134
  v_add_f32 v138, s86, v138
  v_add_f32 v142, s86, v142
  v_add_f32 v146, s86, v146
  v_add_f32 v150, s86, v150
  v_rcp_f32 v122, v122
  v_rcp_f32 v126, v126
  v_rcp_f32 v130, v130
  v_rcp_f32 v134, v134
  v_rcp_f32 v138, v138
  v_rcp_f32 v142, v142
  v_rcp_f32 v146, v146
  v_rcp_f32 v150, v150
  s_waitcnt lgkmcnt(0)
  v_lshlrev_b32 v121, 16, v108
  v_and_b32 v137, 0xffff0000, v108
  v_lshlrev_b32 v125, 16, v109
  v_and_b32 v141, 0xffff0000, v109
  v_lshlrev_b32 v129, 16, v110
  v_and_b32 v145, 0xffff0000, v110
  v_lshlrev_b32 v133, 16, v111
  v_and_b32 v149, 0xffff0000, v111
  v_fma_f32 v120, v120, v122, v121
  v_fma_f32 v124, v124, v126, v125
  v_fma_f32 v128, v128, v130, v129
  v_fma_f32 v132, v132, v134, v133
  v_fma_f32 v136, v136, v138, v137
  v_fma_f32 v140, v140, v142, v141
  v_fma_f32 v144, v144, v146, v145
  v_fma_f32 v148, v148, v150, v149
  v_max_f32 v120, 0, v120
  v_max_f32 v124, 0, v124
  v_max_f32 v128, 0, v128
  v_max_f32 v132, 0, v132
  v_max_f32 v136, 0, v136
  v_max_f32 v140, 0, v140
  v_max_f32 v144, 0, v144
  v_max_f32 v148, 0, v148
  v_lshlrev_b32 v121, 16, v36
  v_and_b32 v137, 0xffff0000, v36
  v_lshlrev_b32 v125, 16, v37
  v_and_b32 v141, 0xffff0000, v37
  v_lshlrev_b32 v129, 16, v38
  v_and_b32 v145, 0xffff0000, v38
  v_lshlrev_b32 v133, 16, v39
  v_and_b32 v149, 0xffff0000, v39
  v_add_f32 v120, v120, v121
  v_add_f32 v124, v124, v125
  v_add_f32 v128, v128, v129
  v_add_f32 v132, v132, v133
  v_add_f32 v136, v136, v137
  v_add_f32 v140, v140, v141
  v_add_f32 v144, v144, v145
  v_add_f32 v148, v148, v149
  v_cvt_pk_bf16_f32 v120, v120, v136
  buffer_store_dword v120, v112, s[12:15], s93 offen
  v_cvt_pk_bf16_f32 v124, v124, v140
  buffer_store_dword v124, v113, s[12:15], s93 offen
  v_cvt_pk_bf16_f32 v128, v128, v144
  buffer_store_dword v128, v114, s[12:15], s93 offen
  v_cvt_pk_bf16_f32 v132, v132, v148
  buffer_store_dword v132, v115, s[12:15], s93 offen
  s_branch K2_EVE
K2_EVS:
  s_cmp_eq_u32 s71, 0
  s_cbranch_scc1 K2_FRL
  v_add_f32 v120, v120, v121
  v_add_f32 v122, v122, v123
  v_add_f32 v124, v124, v125
  v_add_f32 v126, v126, v127
  v_add_f32 v128, v128, v129
  v_add_f32 v130, v130, v131
  v_add_f32 v132, v132, v133
  v_add_f32 v134, v134, v135
  v_add_f32 v136, v136, v137
  v_add_f32 v138, v138, v139
  v_add_f32 v140, v140, v141
  v_add_f32 v142, v142, v143
  v_add_f32 v144, v144, v145
  v_add_f32 v146, v146, v147
  v_add_f32 v148, v148, v149
  v_add_f32 v150, v150, v151
  ds_write2_b32 v20, v120, v122 offset0:64 offset1:128
  ds_write2_b32 v21, v124, v126 offset0:64 offset1:128
  ds_write2_b32 v22, v128, v130 offset0:64 offset1:128
  ds_write2_b32 v23, v132, v134 offset0:64 offset1:128
  ds_write2_b32 v20, v136, v138 offset0:96 offset1:160
  ds_write2_b32 v21, v140, v142 offset0:96 offset1:160
  ds_write2_b32 v22, v144, v146 offset0:96 offset1:160
  ds_write2_b32 v23, v148, v150 offset0:96 offset1:160
  s_branch K2_FEL
K2_FRL:
  ds_read2_b32 v[104:105], v20 offset0:64 offset1:128
  ds_read2_b32 v[106:107], v21 offset0:64 offset1:128
  ds_read2_b32 v[108:109], v22 offset0:64 offset1:128
  ds_read2_b32 v[110:111], v23 offset0:64 offset1:128
  ds_read2_b32 v[112:113], v20 offset0:96 offset1:160
  ds_read2_b32 v[114:115], v21 offset0:96 offset1:160
  ds_read2_b32 v[116:117], v22 offset0:96 offset1:160
  ds_read2_b32 v[118:119], v23 offset0:96 offset1:160
  v_add_f32 v120, v120, v121
  v_add_f32 v122, v122, v123
  v_add_f32 v124, v124, v125
  v_add_f32 v126, v126, v127
  v_add_f32 v128, v128, v129
  v_add_f32 v130, v130, v131
  v_add_f32 v132, v132, v133
  v_add_f32 v134, v134, v135
  v_add_f32 v136, v136, v137
  v_add_f32 v138, v138, v139
  v_add_f32 v140, v140, v141
  v_add_f32 v142, v142, v143
  v_add_f32 v144, v144, v145
  v_add_f32 v146, v146, v147
  v_add_f32 v148, v148, v149
  v_add_f32 v150, v150, v151
  s_waitcnt lgkmcnt(0)
  v_add_f32 v120, v120, v104
  v_add_f32 v122, v122, v105
  v_add_f32 v124, v124, v106
  v_add_f32 v126, v126, v107
  v_add_f32 v128, v128, v108
  v_add_f32 v130, v130, v109
  v_add_f32 v132, v132, v110
  v_add_f32 v134, v134, v111
  v_add_f32 v136, v136, v112
  v_add_f32 v138, v138, v113
  v_add_f32 v140, v140, v114
  v_add_f32 v142, v142, v115
  v_add_f32 v144, v144, v116
  v_add_f32 v146, v146, v117
  v_add_f32 v148, v148, v118
  v_add_f32 v150, v150, v119
  ds_write2_b32 v20, v120, v122 offset0:64 offset1:128
  ds_write2_b32 v21, v124, v126 offset0:64 offset1:128
  ds_write2_b32 v22, v128, v130 offset0:64 offset1:128
  ds_write2_b32 v23, v132, v134 offset0:64 offset1:128
  ds_write2_b32 v20, v136, v138 offset0:96 offset1:160
  ds_write2_b32 v21, v140, v142 offset0:96 offset1:160
  ds_write2_b32 v22, v144, v146 offset0:96 offset1:160
  ds_write2_b32 v23, v148, v150 offset0:96 offset1:160
K2_FEL:
K2_EVE:
  s_cmp_ge_u32 s77, s78
  s_cbranch_scc1 K2_LOOPDONE
  v_mov_b32 v20, v24
  v_mov_b32 v21, v25
  v_mov_b32 v22, v26
  v_mov_b32 v23, v27
  s_mov_b32 s4, s80
  s_add_u32 s86, s80, 1
  s_cmp_lt_u32 s80, s81
  s_cselect_b32 s80, s86, s83
  s_lshl_b32 s86, s80, 5
  v_add_u32 v116, s86, v19
  ds_read_b128 v[24:27], v116
  v_lshrrev_b32 v112, 8, v20
  v_mul_u32_u24 v112, 10923, v112
  v_subrev_u32 v112, 3626436, v112
  v_and_or_b32 v112, v112, s7, v17
  v_lshrrev_b32 v113, 8, v21
  v_mul_u32_u24 v113, 10923, v113
  v_subrev_u32 v113, 3626436, v113
  v_and_or_b32 v113, v113, s7, v17
  v_lshrrev_b32 v114, 8, v22
  v_mul_u32_u24 v114, 10923, v114
  v_subrev_u32 v114, 3626436, v114
  v_and_or_b32 v114, v114, s7, v17
  v_lshrrev_b32 v115, 8, v23
  v_mul_u32_u24 v115, 10923, v115
  v_subrev_u32 v115, 3626436, v115
  v_and_or_b32 v115, v115, s7, v17
  buffer_load_dword v36, v112, s[8:11], s93 offen
  buffer_load_dword v37, v113, s[8:11], s93 offen
  buffer_load_dword v38, v114, s[8:11], s93 offen
  buffer_load_dword v39, v115, s[8:11], s93 offen
  s_bitcmp1_b32 s77, 0
  s_cbranch_scc1 K2_NF0
  s_branch K2_NF1
K2_LOOPDONE:
  s_add_u32 s69, s69, s70
  v_mbcnt_lo_u32_b32 v5, -1, 0
  v_mbcnt_hi_u32_b32 v5, -1, v5
  s_lshl_b32 s86, s68, 6
  v_add_u32 v4, s86, v5
  s_lshl_b32 s86, s68, 12
  s_add_u32 s86, s86, s92
  s_lshl_b32 s86, s86, 7
  v_lshrrev_b32 v61, 5, v5
  v_lshlrev_b32 v14, 17, v61
  v_add3_u32 v14, v14, v17, s86
  ds_read_b32 v108, v20 offset:128
  ds_read_b32 v109, v21 offset:128
  ds_read_b32 v110, v22 offset:128
  ds_read_b32 v111, v23 offset:128
  v_lshrrev_b32 v112, 8, v20
  v_mul_u32_u24 v112, 10923, v112
  v_subrev_u32 v112, 3626436, v112
  v_and_or_b32 v112, v112, s7, v17
  v_lshrrev_b32 v113, 8, v21
  v_mul_u32_u24 v113, 10923, v113
  v_subrev_u32 v113, 3626436, v113
  v_and_or_b32 v113, v113, s7, v17
  v_lshrrev_b32 v114, 8, v22
  v_mul_u32_u24 v114, 10923, v114
  v_subrev_u32 v114, 3626436, v114
  v_and_or_b32 v114, v114, s7, v17
  v_lshrrev_b32 v115, 8, v23
  v_mul_u32_u24 v115, 10923, v115
  v_subrev_u32 v115, 3626436, v115
  v_and_or_b32 v115, v115, s7, v17
K2_NOFL:
  s_cmp_eq_u32 s89, 0
  s_cbranch_scc1 K2_NSL
  v_mov_b32 v60, 51588
  v_mov_b32 v61, 1
  ds_write_b32 v60, v61
K2_NSL:
  v_mov_b32 v60, 51588
  v_add_f32 v120, v120, v121
  v_add_f32 v122, v122, v123
  v_add_f32 v124, v124, v125
  v_add_f32 v126, v126, v127
  v_add_f32 v128, v128, v129
  v_add_f32 v130, v130, v131
  v_add_f32 v132, v132, v133
  v_add_f32 v134, v134, v135
  v_add_f32 v136, v136, v137
  v_add_f32 v138, v138, v139
  v_add_f32 v140, v140, v141
  v_add_f32 v142, v142, v143
  v_add_f32 v144, v144, v145
  v_add_f32 v146, v146, v147
  v_add_f32 v148, v148, v149
  v_add_f32 v150, v150, v151
  s_mov_b32 s77, 1
  s_waitcnt lgkmcnt(0) vmcnt(0)
  s_barrier
  ds_read_b32 v61, v60
K2_MERGE:
  ds_read2_b32 v[40:41], v20 offset0:64 offset1:128
  ds_read2_b32 v[42:43], v21 offset0:64 offset1:128
  ds_read2_b32 v[44:45], v22 offset0:64 offset1:128
  ds_read2_b32 v[46:47], v23 offset0:64 offset1:128
  ds_read2_b32 v[48:49], v20 offset0:96 offset1:160
  ds_read2_b32 v[50:51], v21 offset0:96 offset1:160
  ds_read2_b32 v[52:53], v22 offset0:96 offset1:160
  ds_read2_b32 v[54:55], v23 offset0:96 offset1:160
  s_waitcnt lgkmcnt(8)
  v_readfirstlane_b32 s89, v61
  s_cmp_eq_u32 s82, 0
  s_cbranch_scc1 K2_MNC
  s_cmp_eq_u32 s89, 0
  s_cbranch_scc1 K2_MDO
  s_cmp_lg_u32 s77, s68
  s_cbranch_scc1 K2_MSKIP
K2_MDO:
  s_waitcnt lgkmcnt(0)
  v_add_f32 v120, v120, v40
  v_add_f32 v122, v122, v41
  v_add_f32 v124, v124, v42
  v_add_f32 v126, v126, v43
  v_add_f32 v128, v128, v44
  v_add_f32 v130, v130, v45
  v_add_f32 v132, v132, v46
  v_add_f32 v134, v134, v47
  v_add_f32 v136, v136, v48
  v_add_f32 v138, v138, v49
  v_add_f32 v140, v140, v50
  v_add_f32 v142, v142, v51
  v_add_f32 v144, v144, v52
  v_add_f32 v146, v146, v53
  v_add_f32 v148, v148, v54
  v_add_f32 v150, v150, v55
  s_cmp_lg_u32 s89, 0
  s_cbranch_scc1 K2_MWR
  s_cmp_eq_u32 s3, 0
  s_cbranch_scc1 K2_MWR
  s_mov_b32 s86, 0x358637bd
  v_add_f32 v122, s86, v122
  v_add_f32 v126, s86, v126
  v_add_f32 v130, s86, v130
  v_add_f32 v134, s86, v134
  v_add_f32 v138, s86, v138
  v_add_f32 v142, s86, v142
  v_add_f32 v146, s86, v146
  v_add_f32 v150, s86, v150
  v_rcp_f32 v122, v122
  v_rcp_f32 v126, v126
  v_rcp_f32 v130, v130
  v_rcp_f32 v134, v134
  v_rcp_f32 v138, v138
  v_rcp_f32 v142, v142
  v_rcp_f32 v146, v146
  v_rcp_f32 v150, v150
  s_waitcnt lgkmcnt(0)
  v_lshlrev_b32 v121, 16, v108
  v_and_b32 v137, 0xffff0000, v108
  v_lshlrev_b32 v125, 16, v109
  v_and_b32 v141, 0xffff0000, v109
  v_lshlrev_b32 v129, 16, v110
  v_and_b32 v145, 0xffff0000, v110
  v_lshlrev_b32 v133, 16, v111
  v_and_b32 v149, 0xffff0000, v111
  v_fma_f32 v120, v120, v122, v121
  v_fma_f32 v124, v124, v126, v125
  v_fma_f32 v128, v128, v130, v129
  v_fma_f32 v132, v132, v134, v133
  v_fma_f32 v136, v136, v138, v137
  v_fma_f32 v140, v140, v142, v141
  v_fma_f32 v144, v144, v146, v145
  v_fma_f32 v148, v148, v150, v149
  v_max_f32 v120, 0, v120
  v_max_f32 v124, 0, v124
  v_max_f32 v128, 0, v128
  v_max_f32 v132, 0, v132
  v_max_f32 v136, 0, v136
  v_max_f32 v140, 0, v140
  v_max_f32 v144, 0, v144
  v_max_f32 v148, 0, v148
  v_lshlrev_b32 v121, 16, v36
  v_and_b32 v137, 0xffff0000, v36
  v_lshlrev_b32 v125, 16, v37
  v_and_b32 v141, 0xffff0000, v37
  v_lshlrev_b32 v129, 16, v38
  v_and_b32 v145, 0xffff0000, v38
  v_lshlrev_b32 v133, 16, v39
  v_and_b32 v149, 0xffff0000, v39
  v_add_f32 v120, v120, v121
  v_add_f32 v124, v124, v125
  v_add_f32 v128, v128, v129
  v_add_f32 v132, v132, v133
  v_add_f32 v136, v136, v137
  v_add_f32 v140, v140, v141
  v_add_f32 v144, v144, v145
  v_add_f32 v148, v148, v149
  v_cvt_pk_bf16_f32 v120, v120, v136
  buffer_store_dword v120, v112, s[12:15], s93 offen
  v_cvt_pk_bf16_f32 v124, v124, v140
  buffer_store_dword v124, v113, s[12:15], s93 offen
  v_cvt_pk_bf16_f32 v128, v128, v144
  buffer_store_dword v128, v114, s[12:15], s93 offen
  v_cvt_pk_bf16_f32 v132, v132, v148
  buffer_store_dword v132, v115, s[12:15], s93 offen
  s_endpgm
K2_MWR:
  ds_write2_b32 v20, v120, v122 offset0:64 offset1:128
  ds_write2_b32 v21, v124, v126 offset0:64 offset1:128
  ds_write2_b32 v22, v128, v130 offset0:64 offset1:128
  ds_write2_b32 v23, v132, v134 offset0:64 offset1:128
  ds_write2_b32 v20, v136, v138 offset0:96 offset1:160
  ds_write2_b32 v21, v140, v142 offset0:96 offset1:160
  ds_write2_b32 v22, v144, v146 offset0:96 offset1:160
  ds_write2_b32 v23, v148, v150 offset0:96 offset1:160
  s_branch K2_MSKIP
K2_MNC:
  s_cmp_lg_u32 s89, 0
  s_cbranch_scc1 K2_MSKIP
  s_cmp_lg_u32 s3, 0
  s_cbranch_scc1 K2_FIN
K2_MSKIP:
  s_waitcnt lgkmcnt(0)
  s_barrier
  s_cmp_eq_u32 s89, 0
  s_cbranch_scc1 K2_MEND
  s_add_u32 s77, s77, 1
  s_cmp_lt_u32 s77, 8
  s_cbranch_scc1 K2_MERGE
K2_MEND:
  s_mov_b32 s71, 0
  s_cmp_gt_u32 s85, s69
  s_cbranch_scc1 K2_RESET
  s_mov_b32 s60, 0
  buffer_load_dword v40, v14, s[8:11], s60 offen
  s_mov_b32 s61, 32768
  buffer_load_dword v41, v14, s[8:11], s61 offen
  s_mov_b32 s62, 65536
  buffer_load_dword v42, v14, s[8:11], s62 offen
  s_mov_b32 s63, 98304
  buffer_load_dword v43, v14, s[8:11], s63 offen
  s_mov_b32 s64, 262144
  buffer_load_dword v44, v14, s[8:11], s64 offen
  s_mov_b32 s65, 294912
  buffer_load_dword v45, v14, s[8:11], s65 offen
  s_mov_b32 s66, 327680
  buffer_load_dword v46, v14, s[8:11], s66 offen
  s_mov_b32 s67, 360448
  buffer_load_dword v47, v14, s[8:11], s67 offen
  s_mul_i32 s86, s68, 12288
  s_add_u32 s86, s86, 84992
  v_lshrrev_b32 v37, 5, v5
  v_mul_u32_u24 v37, 3072, v37
  v_add3_u32 v37, v37, v17, s86
  v_add_u32 v38, 128, v37
  ds_read2st64_b32 v[120:121], v37 offset0:1 offset1:2
  ds_read2st64_b32 v[122:123], v38 offset0:1 offset1:2
  ds_read_b32 v104, v38 offset:0
  ds_read2st64_b32 v[124:125], v37 offset0:4 offset1:5
  ds_read2st64_b32 v[126:127], v38 offset0:4 offset1:5
  ds_read_b32 v105, v38 offset:768
  ds_read2st64_b32 v[128:129], v37 offset0:7 offset1:8
  ds_read2st64_b32 v[130:131], v38 offset0:7 offset1:8
  ds_read_b32 v106, v38 offset:1536
  ds_read2st64_b32 v[132:133], v37 offset0:10 offset1:11
  ds_read2st64_b32 v[134:135], v38 offset0:10 offset1:11
  ds_read_b32 v107, v38 offset:2304
  ds_read2st64_b32 v[136:137], v37 offset0:25 offset1:26
  ds_read2st64_b32 v[138:139], v38 offset0:25 offset1:26
  ds_read_b32 v108, v38 offset:6144
  ds_read2st64_b32 v[140:141], v37 offset0:28 offset1:29
  ds_read2st64_b32 v[142:143], v38 offset0:28 offset1:29
  ds_read_b32 v109, v38 offset:6912
  ds_read2st64_b32 v[144:145], v37 offset0:31 offset1:32
  ds_read2st64_b32 v[146:147], v38 offset0:31 offset1:32
  ds_read_b32 v110, v38 offset:7680
  ds_read2st64_b32 v[148:149], v37 offset0:34 offset1:35
  ds_read2st64_b32 v[150:151], v38 offset0:34 offset1:35
  ds_read_b32 v111, v38 offset:8448
  s_mov_b32 s86, 0x358637bd
  s_waitcnt lgkmcnt(15)
  v_add_f32 v121, s86, v121
  v_add_f32 v123, s86, v123
  v_rcp_f32 v121, v121
  v_rcp_f32 v123, v123
  v_lshlrev_b32 v112, 16, v104
  v_and_b32 v104, 0xffff0000, v104
  s_waitcnt lgkmcnt(15)
  v_add_f32 v125, s86, v125
  v_add_f32 v127, s86, v127
  v_rcp_f32 v125, v125
  v_rcp_f32 v127, v127
  v_lshlrev_b32 v113, 16, v105
  v_and_b32 v105, 0xffff0000, v105
  s_waitcnt lgkmcnt(15)
  v_add_f32 v129, s86, v129
  v_add_f32 v131, s86, v131
  v_rcp_f32 v129, v129
  v_rcp_f32 v131, v131
  v_lshlrev_b32 v114, 16, v106
  v_and_b32 v106, 0xffff0000, v106
  s_waitcnt lgkmcnt(12)
  v_add_f32 v133, s86, v133
  v_add_f32 v135, s86, v135
  v_rcp_f32 v133, v133
  v_rcp_f32 v135, v135
  v_lshlrev_b32 v115, 16, v107
  v_and_b32 v107, 0xffff0000, v107
  s_waitcnt lgkmcnt(9)
  v_add_f32 v137, s86, v137
  v_add_f32 v139, s86, v139
  v_rcp_f32 v137, v137
  v_rcp_f32 v139, v139
  v_lshlrev_b32 v116, 16, v108
  v_and_b32 v108, 0xffff0000, v108
  s_waitcnt lgkmcnt(6)
  v_add_f32 v141, s86, v141
  v_add_f32 v143, s86, v143
  v_rcp_f32 v141, v141
  v_rcp_f32 v143, v143
  v_lshlrev_b32 v117, 16, v109
  v_and_b32 v109, 0xffff0000, v109
  s_waitcnt lgkmcnt(3)
  v_add_f32 v145, s86, v145
  v_add_f32 v147, s86, v147
  v_rcp_f32 v145, v145
  v_rcp_f32 v147, v147
  v_lshlrev_b32 v118, 16, v110
  v_and_b32 v110, 0xffff0000, v110
  s_waitcnt lgkmcnt(0)
  v_add_f32 v149, s86, v149
  v_add_f32 v151, s86, v151
  v_rcp_f32 v149, v149
  v_rcp_f32 v151, v151
  v_lshlrev_b32 v119, 16, v111
  v_and_b32 v111, 0xffff0000, v111
  s_waitcnt vmcnt(0)
  v_fma_f32 v120, v120, v121, v112
  v_fma_f32 v122, v122, v123, v104
  v_lshlrev_b32 v121, 16, v40
  v_and_b32 v123, 0xffff0000, v40
  v_max_f32 v120, 0, v120
  v_max_f32 v122, 0, v122
  v_add_f32 v120, v120, v121
  v_add_f32 v122, v122, v123
  v_cvt_pk_bf16_f32 v120, v120, v122
  buffer_store_dword v120, v14, s[12:15], s60 offen
  v_fma_f32 v124, v124, v125, v113
  v_fma_f32 v126, v126, v127, v105
  v_lshlrev_b32 v125, 16, v41
  v_and_b32 v127, 0xffff0000, v41
  v_max_f32 v124, 0, v124
  v_max_f32 v126, 0, v126
  v_add_f32 v124, v124, v125
  v_add_f32 v126, v126, v127
  v_cvt_pk_bf16_f32 v124, v124, v126
  buffer_store_dword v124, v14, s[12:15], s61 offen
  v_fma_f32 v128, v128, v129, v114
  v_fma_f32 v130, v130, v131, v106
  v_lshlrev_b32 v129, 16, v42
  v_and_b32 v131, 0xffff0000, v42
  v_max_f32 v128, 0, v128
  v_max_f32 v130, 0, v130
  v_add_f32 v128, v128, v129
  v_add_f32 v130, v130, v131
  v_cvt_pk_bf16_f32 v128, v128, v130
  buffer_store_dword v128, v14, s[12:15], s62 offen
  v_fma_f32 v132, v132, v133, v115
  v_fma_f32 v134, v134, v135, v107
  v_lshlrev_b32 v133, 16, v43
  v_and_b32 v135, 0xffff0000, v43
  v_max_f32 v132, 0, v132
  v_max_f32 v134, 0, v134
  v_add_f32 v132, v132, v133
  v_add_f32 v134, v134, v135
  v_cvt_pk_bf16_f32 v132, v132, v134
  buffer_store_dword v132, v14, s[12:15], s63 offen
  v_fma_f32 v136, v136, v137, v116
  v_fma_f32 v138, v138, v139, v108
  v_lshlrev_b32 v137, 16, v44
  v_and_b32 v139, 0xffff0000, v44
  v_max_f32 v136, 0, v136
  v_max_f32 v138, 0, v138
  v_add_f32 v136, v136, v137
  v_add_f32 v138, v138, v139
  v_cvt_pk_bf16_f32 v136, v136, v138
  buffer_store_dword v136, v14, s[12:15], s64 offen
  v_fma_f32 v140, v140, v141, v117
  v_fma_f32 v142, v142, v143, v109
  v_lshlrev_b32 v141, 16, v45
  v_and_b32 v143, 0xffff0000, v45
  v_max_f32 v140, 0, v140
  v_max_f32 v142, 0, v142
  v_add_f32 v140, v140, v141
  v_add_f32 v142, v142, v143
  v_cvt_pk_bf16_f32 v140, v140, v142
  buffer_store_dword v140, v14, s[12:15], s65 offen
  v_fma_f32 v144, v144, v145, v118
  v_fma_f32 v146, v146, v147, v110
  v_lshlrev_b32 v145, 16, v46
  v_and_b32 v147, 0xffff0000, v46
  v_max_f32 v144, 0, v144
  v_max_f32 v146, 0, v146
  v_add_f32 v144, v144, v145
  v_add_f32 v146, v146, v147
  v_cvt_pk_bf16_f32 v144, v144, v146
  buffer_store_dword v144, v14, s[12:15], s66 offen
  v_fma_f32 v148, v148, v149, v119
  v_fma_f32 v150, v150, v151, v111
  v_lshlrev_b32 v149, 16, v47
  v_and_b32 v151, 0xffff0000, v47
  v_max_f32 v148, 0, v148
  v_max_f32 v150, 0, v150
  v_add_f32 v148, v148, v149
  v_add_f32 v150, v150, v151
  v_cvt_pk_bf16_f32 v148, v148, v150
  buffer_store_dword v148, v14, s[12:15], s67 offen
K2_FIN:
K2_END:
  s_endpgm
.section .rodata,"a"
.p2align 6
.amdhsa_kernel part_kernel
  .amdhsa_next_free_vgpr 56
  .amdhsa_next_free_sgpr 32
  .amdhsa_accum_offset 56
  .amdhsa_group_segment_fixed_size 0
  .amdhsa_kernarg_size 96
  .amdhsa_user_sgpr_count 2
  .amdhsa_user_sgpr_kernarg_segment_ptr 1
  .amdhsa_system_sgpr_workgroup_id_x 1
  .amdhsa_float_denorm_mode_32 3
.end_amdhsa_kernel
.p2align 6
.amdhsa_kernel main_kernel
  .amdhsa_next_free_vgpr 254
  .amdhsa_next_free_sgpr 100
  .amdhsa_accum_offset 152
  .amdhsa_group_segment_fixed_size 0
  .amdhsa_kernarg_size 96
  .amdhsa_user_sgpr_count 2
  .amdhsa_user_sgpr_kernarg_segment_ptr 1
  .amdhsa_system_sgpr_workgroup_id_x 1
  .amdhsa_float_denorm_mode_32 3
.end_amdhsa_kernel
```
